```python
import torch

def _softmax(x, axis=-1):
    return torch.softmax(x, dim=axis)

def _gelu(x):
    return torch.nn.functional.gelu(x, approximate='tanh')

def _silu(x):
    return torch.nn.functional.silu(x)

def _sigmoid(x):
    return torch.sigmoid(x)

def _layernorm(x, axis=-1, eps=1e-05):
    m = x.mean(dim=axis, keepdim=True)
    v = x.var(dim=axis, keepdim=True, unbiased=False)
    return (x - m) / torch.sqrt(v + eps)

def _scatter_add(tgt, idx, src, axis=0):
    return tgt.clone().index_add_(axis, idx, src)

def _segment_sum(src, seg, n):
    out = torch.zeros((n,) + src.shape[1:], dtype=src.dtype)
    return out.index_add_(0, seg, src)

def _pad(x, pw):
    flat = tuple((v for pair in reversed(pw) for v in pair))
    return torch.nn.functional.pad(x, flat)
kernel_name = 'standalone__dilated_atrous__vision'

def setup_inputs():

    _w = lambda a: (lambda t: t.to(torch.bfloat16) if t.is_floating_point() else t)(torch.as_tensor(a))
    H = W = 384
    C = 96
    k = 3
    return {'x': _w((lambda *s: torch.randn(*s, dtype=torch.bfloat16) * 0.05)(1, H, W, C)), 'w': _w((lambda *s: torch.randn(*s, dtype=torch.bfloat16) * 0.05)(k, k, C, C) * (1.0 / (k * C ** 0.5)))}

def reference(x, w):
    B, H, W, C = x.shape
    k = 3
    rate = 2
    pad = (k - 1) * rate // 2
    xp = _pad(x, ((0, 0), (pad, pad), (pad, pad), (0, 0)))
    out = torch.zeros_like(x)
    for i in range(k):
        for j in range(k):
            tap = xp[:, i * rate:i * rate + H, j * rate:j * rate + W, :].clone()
            out = out + torch.einsum('bhwc,co->bhwo', tap, w[i, j])
    return out
```

```asm
; @launch grid=(256,1,1) block=(256,1,1) lds=163840
.amdgcn_target "amdgcn-amd-amdhsa--gfx950"
.text
.globl standalone__dilated_atrous__vision_kernel
.p2align 8
.type standalone__dilated_atrous__vision_kernel,@function
standalone__dilated_atrous__vision_kernel:
    s_cmp_ge_u32 s2, 256
    s_cbranch_scc1 L_end
    s_load_dwordx4 s[4:7], s[0:1], 0
    s_load_dwordx2 s[12:13], s[0:1], 16
    s_getpc_b64 s[60:61]
    v_mul_u32_u24 v192, 128, v0
    v_mov_b32 v193, 0
    v_min_u32 v192, 21148, v192
    v_add_co_u32 v192, vcc, s60, v192
    v_mov_b32 v194, s61
    v_addc_co_u32 v193, vcc, v194, v193, vcc
    global_load_dword v250, v[192:193], off
    v_lshrrev_b32 v190, 6, v0
    v_and_b32 v1, 63, v0
    s_nop 0
    v_readfirstlane_b32 s20, v190
    s_lshr_b32 s30, s2, 3
    s_and_b32 s31, s30, 7
    s_mul_i32 s23, s31, 48
    s_bfe_u32 s31, s2, 0x10006
    s_and_b32 s35, s2, 7
    s_lshl_b32 s35, s35, 1
    s_lshr_b32 s30, s2, 7
    s_add_u32 s35, s35, s30
    s_mul_i32 s24, s35, 24
    s_add_u32 s24, s24, s31
    s_nop 1
    s_and_b32 s21, s20, 1
    s_lshr_b32 s22, s20, 1
    s_lshl_b32 s30, s20, 10
    v_lshlrev_b32 v14, 4, v1
    v_add_u32 v14, s30, v14
    s_add_u32 s28, s30, 90112
    s_mul_i32 s30, s21, 320
    s_sub_u32 s31, s23, 2
    v_mov_b32 v199, 0x7fff
    v_mov_b32 v200, 192
    v_mov_b32 v201, 0x180
    v_mov_b32 v202, 0x80000000
    v_add_u32 v203, s30, v1
    v_mul_u32_u24 v191, 1366, v203
    v_lshrrev_b32 v191, 16, v191
    v_mul_u32_u24 v192, 48, v191
    v_sub_u32 v192, v203, v192
    v_lshrrev_b32 v193, 3, v192
    v_and_b32 v194, 1, v191
    v_xor_b32 v193, v193, v194
    v_bfe_u32 v194, v192, 1, 2
    v_lshl_add_u32 v194, v191, 2, v194
    v_cmp_gt_u32 vcc, 52, v194
    v_and_b32 v195, 1, v192
    v_lshlrev_b32 v195, 4, v195
    v_lshl_add_u32 v195, v193, 5, v195
    v_mul_u32_u24 v197, 3641, v194
    v_lshrrev_b32 v197, 16, v197
    v_mul_u32_u24 v198, 18, v197
    v_sub_u32 v198, v194, v198
    v_and_b32 v196, 1, v198
    v_sub_u32 v197, v197, v196
    v_mul_u32_u24 v198, 3, v198
    v_lshl_add_u32 v198, v197, 1, v198
    v_add_u32 v196, s31, v198
    v_cndmask_b32 v196, v199, v196, vcc
    v_cmp_gt_u32 vcc, v201, v196
    v_mad_u32_u24 v195, v196, v200, v195
    s_nop 0
    v_cndmask_b32 v2, v202, v195, vcc
    v_add_u32 v190, 64, v203
    v_mul_u32_u24 v191, 1366, v190
    v_lshrrev_b32 v191, 16, v191
    v_mul_u32_u24 v192, 48, v191
    v_sub_u32 v192, v190, v192
    v_lshrrev_b32 v193, 3, v192
    v_and_b32 v194, 1, v191
    v_xor_b32 v193, v193, v194
    v_bfe_u32 v194, v192, 1, 2
    v_lshl_add_u32 v194, v191, 2, v194
    v_cmp_gt_u32 vcc, 52, v194
    v_and_b32 v195, 1, v192
    v_lshlrev_b32 v195, 4, v195
    v_lshl_add_u32 v195, v193, 5, v195
    v_mul_u32_u24 v197, 3641, v194
    v_lshrrev_b32 v197, 16, v197
    v_mul_u32_u24 v198, 18, v197
    v_sub_u32 v198, v194, v198
    v_and_b32 v196, 1, v198
    v_sub_u32 v197, v197, v196
    v_mul_u32_u24 v198, 3, v198
    v_lshl_add_u32 v198, v197, 1, v198
    v_add_u32 v196, s31, v198
    v_cndmask_b32 v196, v199, v196, vcc
    v_cmp_gt_u32 vcc, v201, v196
    v_mad_u32_u24 v195, v196, v200, v195
    s_nop 0
    v_cndmask_b32 v3, v202, v195, vcc
    v_add_u32 v190, 128, v203
    v_mul_u32_u24 v191, 1366, v190
    v_lshrrev_b32 v191, 16, v191
    v_mul_u32_u24 v192, 48, v191
    v_sub_u32 v192, v190, v192
    v_lshrrev_b32 v193, 3, v192
    v_and_b32 v194, 1, v191
    v_xor_b32 v193, v193, v194
    v_bfe_u32 v194, v192, 1, 2
    v_lshl_add_u32 v194, v191, 2, v194
    v_cmp_gt_u32 vcc, 52, v194
    v_and_b32 v195, 1, v192
    v_lshlrev_b32 v195, 4, v195
    v_lshl_add_u32 v195, v193, 5, v195
    v_mul_u32_u24 v197, 3641, v194
    v_lshrrev_b32 v197, 16, v197
    v_mul_u32_u24 v198, 18, v197
    v_sub_u32 v198, v194, v198
    v_and_b32 v196, 1, v198
    v_sub_u32 v197, v197, v196
    v_mul_u32_u24 v198, 3, v198
    v_lshl_add_u32 v198, v197, 1, v198
    v_add_u32 v196, s31, v198
    v_cndmask_b32 v196, v199, v196, vcc
    v_cmp_gt_u32 vcc, v201, v196
    v_mad_u32_u24 v195, v196, v200, v195
    s_nop 0
    v_cndmask_b32 v4, v202, v195, vcc
    v_add_u32 v190, 192, v203
    v_mul_u32_u24 v191, 1366, v190
    v_lshrrev_b32 v191, 16, v191
    v_mul_u32_u24 v192, 48, v191
    v_sub_u32 v192, v190, v192
    v_lshrrev_b32 v193, 3, v192
    v_and_b32 v194, 1, v191
    v_xor_b32 v193, v193, v194
    v_bfe_u32 v194, v192, 1, 2
    v_lshl_add_u32 v194, v191, 2, v194
    v_cmp_gt_u32 vcc, 52, v194
    v_and_b32 v195, 1, v192
    v_lshlrev_b32 v195, 4, v195
    v_lshl_add_u32 v195, v193, 5, v195
    v_mul_u32_u24 v197, 3641, v194
    v_lshrrev_b32 v197, 16, v197
    v_mul_u32_u24 v198, 18, v197
    v_sub_u32 v198, v194, v198
    v_and_b32 v196, 1, v198
    v_sub_u32 v197, v197, v196
    v_mul_u32_u24 v198, 3, v198
    v_lshl_add_u32 v198, v197, 1, v198
    v_add_u32 v196, s31, v198
    v_cndmask_b32 v196, v199, v196, vcc
    v_cmp_gt_u32 vcc, v201, v196
    v_mad_u32_u24 v195, v196, v200, v195
    s_nop 0
    v_cndmask_b32 v5, v202, v195, vcc
    v_add_u32 v190, 256, v203
    v_mul_u32_u24 v191, 1366, v190
    v_lshrrev_b32 v191, 16, v191
    v_mul_u32_u24 v192, 48, v191
    v_sub_u32 v192, v190, v192
    v_lshrrev_b32 v193, 3, v192
    v_and_b32 v194, 1, v191
    v_xor_b32 v193, v193, v194
    v_bfe_u32 v194, v192, 1, 2
    v_lshl_add_u32 v194, v191, 2, v194
    v_cmp_gt_u32 vcc, 52, v194
    v_and_b32 v195, 1, v192
    v_lshlrev_b32 v195, 4, v195
    v_lshl_add_u32 v195, v193, 5, v195
    v_mul_u32_u24 v197, 3641, v194
    v_lshrrev_b32 v197, 16, v197
    v_mul_u32_u24 v198, 18, v197
    v_sub_u32 v198, v194, v198
    v_and_b32 v196, 1, v198
    v_sub_u32 v197, v197, v196
    v_mul_u32_u24 v198, 3, v198
    v_lshl_add_u32 v198, v197, 1, v198
    v_add_u32 v196, s31, v198
    v_cndmask_b32 v196, v199, v196, vcc
    v_cmp_gt_u32 vcc, v201, v196
    v_mad_u32_u24 v195, v196, v200, v195
    s_nop 0
    v_cndmask_b32 v6, v202, v195, vcc
    s_mul_i32 s27, s20, 5120
    s_and_b32 s30, s35, 1
    s_cmp_lt_u32 s30, 1
    s_cselect_b32 s31, -2, 2
    s_cselect_b32 s32, 22, 0
    s_cselect_b32 s40, 110592, 0
    s_mul_i32 s44, s31, 147456
    s_mul_i32 s30, s22, s31
    s_add_u32 s30, s30, s24
    s_add_u32 s30, s30, s32
    s_mul_i32 s33, s30, 73728
    s_sub_u32 s30, s30, s31
    s_mul_i32 s25, s30, 73728
    s_sub_u32 s42, 0, s40
    s_cmp_lt_u32 s20, 2
    s_cselect_b32 s41, s40, 0
    s_cselect_b32 s43, s42, 0x40000000
    s_cselect_b32 s46, 0, 12288
    s_cselect_b32 s49, 0, -36864
    s_add_u32 s45, s46, s40
    s_add_u32 s47, s46, s42
    s_add_u32 s48, s49, s40
    s_add_u32 s50, s49, s42
    s_waitcnt lgkmcnt(0)
    s_mov_b32 s8, s6
    s_and_b32 s9, s7, 0xffff
    s_mov_b32 s10, 165888
    s_mov_b32 s11, 0x00020000
    s_and_b32 s5, s5, 0xffff
    s_mov_b32 s6, 28311552
    s_mov_b32 s7, 0x00020000
    s_and_b32 s13, s13, 0xffff
    s_mov_b32 s14, 28311552
    s_mov_b32 s15, 0x00020000
    s_add_u32 m0, s28, 0
    s_add_u32 s29, s40, 0
    buffer_load_dwordx4 v14, s[8:11], s29 offen lds
    s_add_u32 m0, s28, 4096
    s_add_u32 s29, s45, 4096
    buffer_load_dwordx4 v14, s[8:11], s29 offen lds
    s_add_u32 m0, s28, 8192
    s_add_u32 s29, s40, 20480
    buffer_load_dwordx4 v14, s[8:11], s29 offen lds
    s_add_u32 m0, s28, 12288
    s_add_u32 s29, s40, 36864
    buffer_load_dwordx4 v14, s[8:11], s29 offen lds
    s_add_u32 m0, s28, 16384
    s_add_u32 s29, s48, 40960
    buffer_load_dwordx4 v14, s[8:11], s29 offen lds
    s_add_u32 m0, s27, 0
    s_cmp_lt_i32 s25, 0
    s_cselect_b32 s26, 0x40000000, s25
    buffer_load_dwordx4 v2, s[4:7], s26 offen nt lds
    s_add_u32 m0, s27, 1024
    s_add_u32 s25, s25, s44
    buffer_load_dwordx4 v3, s[4:7], s26 offen nt lds
    s_add_u32 m0, s27, 2048
    s_nop 0
    buffer_load_dwordx4 v4, s[4:7], s26 offen nt lds
    s_add_u32 m0, s27, 3072
    s_nop 0
    buffer_load_dwordx4 v5, s[4:7], s26 offen nt lds
    s_add_u32 m0, s27, 4096
    s_nop 0
    buffer_load_dwordx4 v6, s[4:7], s26 offen nt lds
    v_and_b32 v190, 15, v1
    v_lshrrev_b32 v191, 4, v1
    v_lshrrev_b32 v192, 1, v191
    v_and_b32 v193, 1, v191
    s_mul_i32 s30, s22, 10240
    v_add_u32 v194, 0, v190
    v_lshrrev_b32 v195, 2, v194
    v_and_b32 v196, 1, v195
    v_xor_b32 v196, v196, v192
    v_mul_u32_u24 v195, 768, v195
    v_lshl_add_u32 v195, v196, 7, v195
    v_and_b32 v194, 3, v194
    v_lshl_add_u32 v195, v194, 5, v195
    v_lshl_add_u32 v195, v193, 4, v195
    v_add_u32 v7, s30, v195
    v_add_u32 v194, 2, v190
    v_lshrrev_b32 v195, 2, v194
    v_and_b32 v196, 1, v195
    v_xor_b32 v196, v196, v192
    v_mul_u32_u24 v195, 768, v195
    v_lshl_add_u32 v195, v196, 7, v195
    v_and_b32 v194, 3, v194
    v_lshl_add_u32 v195, v194, 5, v195
    v_lshl_add_u32 v195, v193, 4, v195
    v_add_u32 v8, s30, v195
    v_add_u32 v194, 4, v190
    v_lshrrev_b32 v195, 2, v194
    v_and_b32 v196, 1, v195
    v_xor_b32 v196, v196, v192
    v_mul_u32_u24 v195, 768, v195
    v_lshl_add_u32 v195, v196, 7, v195
    v_and_b32 v194, 3, v194
    v_lshl_add_u32 v195, v194, 5, v195
    v_lshl_add_u32 v195, v193, 4, v195
    v_add_u32 v9, s30, v195
    v_bfe_u32 v194, v1, 2, 2
    v_lshl_add_u32 v194, v191, 3, v194
    v_mul_u32_u24 v194, 192, v194
    v_and_b32 v195, 3, v1
    s_mul_i32 s30, s21, 96
    s_add_u32 s31, s30, 90112
    v_add_u32 v194, s31, v194
    v_lshl_add_u32 v10, v195, 4, v194
    v_lshl_add_u32 v12, v195, 3, v194
    v_add_u32 v12, 64, v12
    v_add_u32 v11, 36864, v10
    v_add_u32 v13, 36864, v12
    s_mul_i32 s30, s22, 9600
    s_mul_i32 s31, s21, 6
    v_lshrrev_b32 v194, 2, v190
    v_mul_u32_u24 v195, 192, v190
    v_add_u32 v195, s30, v195
    v_add_u32 v196, s31, v191
    v_xor_b32 v196, v196, v194
    v_lshl_add_u32 v206, v196, 4, v195
    v_add_u32 v196, s31, v192
    v_add_u32 v196, 4, v196
    v_xor_b32 v196, v196, v194
    v_lshl_add_u32 v195, v193, 3, v195
    v_lshl_add_u32 v207, v196, 4, v195
    s_mul_i32 s32, s21, 24
    v_add_u32 v194, 0, v1
    v_mul_u32_u24 v195, 5462, v194
    v_lshrrev_b32 v195, 16, v195
    v_mul_u32_u24 v196, 12, v195
    v_sub_u32 v196, v194, v196
    v_add_u32 v195, s32, v195
    v_mul_u32_u24 v197, 10923, v195
    v_lshrrev_b32 v197, 16, v197
    v_mul_u32_u24 v198, 6, v197
    v_sub_u32 v198, v195, v198
    v_and_b32 v195, 1, v195
    v_lshl_add_u32 v195, v197, 1, v195
    v_lshrrev_b32 v198, 1, v198
    v_bfe_u32 v197, v195, 2, 2
    v_xor_b32 v196, v196, v197
    v_mul_u32_u24 v195, 192, v195
    v_lshl_add_u32 v195, v196, 4, v195
    v_mul_u32_u24 v198, 3200, v198
    v_add3_u32 v208, s30, v195, v198
    v_add_u32 v194, 64, v1
    v_mul_u32_u24 v195, 5462, v194
    v_lshrrev_b32 v195, 16, v195
    v_mul_u32_u24 v196, 12, v195
    v_sub_u32 v196, v194, v196
    v_add_u32 v195, s32, v195
    v_mul_u32_u24 v197, 10923, v195
    v_lshrrev_b32 v197, 16, v197
    v_mul_u32_u24 v198, 6, v197
    v_sub_u32 v198, v195, v198
    v_and_b32 v195, 1, v195
    v_lshl_add_u32 v195, v197, 1, v195
    v_lshrrev_b32 v198, 1, v198
    v_bfe_u32 v197, v195, 2, 2
    v_xor_b32 v196, v196, v197
    v_mul_u32_u24 v195, 192, v195
    v_lshl_add_u32 v195, v196, 4, v195
    v_mul_u32_u24 v198, 3200, v198
    v_add3_u32 v209, s30, v195, v198
    v_add_u32 v194, 128, v1
    v_mul_u32_u24 v195, 5462, v194
    v_lshrrev_b32 v195, 16, v195
    v_mul_u32_u24 v196, 12, v195
    v_sub_u32 v196, v194, v196
    v_add_u32 v195, s32, v195
    v_mul_u32_u24 v197, 10923, v195
    v_lshrrev_b32 v197, 16, v197
    v_mul_u32_u24 v198, 6, v197
    v_sub_u32 v198, v195, v198
    v_and_b32 v195, 1, v195
    v_lshl_add_u32 v195, v197, 1, v195
    v_lshrrev_b32 v198, 1, v198
    v_bfe_u32 v197, v195, 2, 2
    v_xor_b32 v196, v196, v197
    v_mul_u32_u24 v195, 192, v195
    v_lshl_add_u32 v195, v196, 4, v195
    v_mul_u32_u24 v198, 3200, v198
    v_add3_u32 v210, s30, v195, v198
    v_add_u32 v194, 192, v1
    v_mul_u32_u24 v195, 5462, v194
    v_lshrrev_b32 v195, 16, v195
    v_mul_u32_u24 v196, 12, v195
    v_sub_u32 v196, v194, v196
    v_add_u32 v195, s32, v195
    v_mul_u32_u24 v197, 10923, v195
    v_lshrrev_b32 v197, 16, v197
    v_mul_u32_u24 v198, 6, v197
    v_sub_u32 v198, v195, v198
    v_and_b32 v195, 1, v195
    v_lshl_add_u32 v195, v197, 1, v195
    v_lshrrev_b32 v198, 1, v198
    v_bfe_u32 v197, v195, 2, 2
    v_xor_b32 v196, v196, v197
    v_mul_u32_u24 v195, 192, v195
    v_lshl_add_u32 v195, v196, 4, v195
    v_mul_u32_u24 v198, 3200, v198
    v_add3_u32 v232, s30, v195, v198
    v_add_u32 v194, 256, v1
    v_mul_u32_u24 v195, 5462, v194
    v_lshrrev_b32 v195, 16, v195
    v_mul_u32_u24 v196, 12, v195
    v_sub_u32 v196, v194, v196
    v_add_u32 v195, s32, v195
    v_mul_u32_u24 v197, 10923, v195
    v_lshrrev_b32 v197, 16, v197
    v_mul_u32_u24 v198, 6, v197
    v_sub_u32 v198, v195, v198
    v_and_b32 v195, 1, v195
    v_lshl_add_u32 v195, v197, 1, v195
    v_lshrrev_b32 v198, 1, v198
    v_bfe_u32 v197, v195, 2, 2
    v_xor_b32 v196, v196, v197
    v_mul_u32_u24 v195, 192, v195
    v_lshl_add_u32 v195, v196, 4, v195
    v_mul_u32_u24 v198, 3200, v198
    v_add3_u32 v233, s30, v195, v198
    s_mul_i32 s31, s21, 4608
    s_mul_i32 s30, s23, 192
    s_add_u32 s30, s30, s31
    v_lshlrev_b32 v194, 4, v1
    v_add_u32 v15, s30, v194
    v_add_u32 v194, 4096, v15
    v_cmp_gt_u32 vcc, 32, v1
    v_mov_b32 v195, 0x80000000
    s_nop 0
    v_cndmask_b32 v188, v195, v194, vcc
    s_add_u32 m0, s28, 20480
    s_add_u32 s29, s40, 8192
    buffer_load_dwordx4 v14, s[8:11], s29 offen lds
    s_add_u32 m0, s28, 24576
    s_add_u32 s29, s40, 24576
    buffer_load_dwordx4 v14, s[8:11], s29 offen lds
    s_add_u32 m0, s28, 28672
    s_add_u32 s29, s45, 28672
    buffer_load_dwordx4 v14, s[8:11], s29 offen lds
    s_add_u32 m0, s28, 32768
    s_add_u32 s29, s40, 45056
    buffer_load_dwordx4 v14, s[8:11], s29 offen lds
    s_add_u32 m0, s28, 36864
    s_add_u32 s29, s40, 12288
    buffer_load_dwordx4 v14, s[8:11], s29 offen lds
    s_add_u32 m0, s28, 40960
    s_add_u32 s29, s45, 16384
    buffer_load_dwordx4 v14, s[8:11], s29 offen lds
    s_add_u32 m0, s28, 45056
    s_add_u32 s29, s40, 32768
    buffer_load_dwordx4 v14, s[8:11], s29 offen lds
    s_add_u32 m0, s28, 49152
    s_add_u32 s29, s40, 49152
    buffer_load_dwordx4 v14, s[8:11], s29 offen lds
    s_add_u32 m0, s28, 53248
    s_add_u32 s29, s41, 53248
    buffer_load_dwordx4 v14, s[8:11], s29 offen lds
    s_add_u32 m0, s27, 20480
    s_mov_b32 s26, s25
    buffer_load_dwordx4 v2, s[4:7], s26 offen nt lds
    s_waitcnt vmcnt(10)
    s_barrier
    ds_read_b64_tr_b16 a[0:1], v10 offset:0
    ds_read_b64_tr_b16 a[2:3], v10 offset:768
    ds_read_b64_tr_b16 a[12:13], v10 offset:6144
    ds_read_b64_tr_b16 a[14:15], v10 offset:6912
    ds_read_b64_tr_b16 a[24:25], v10 offset:12288
    ds_read_b64_tr_b16 a[26:27], v10 offset:13056
    ds_read_b128 v[16:19], v7 offset:0
    ds_read_b128 v[20:23], v8 offset:3072
    ds_read_b128 v[24:27], v9 offset:6144
    ds_read_b64_tr_b16 a[4:5], v10 offset:8
    ds_read_b64_tr_b16 a[6:7], v10 offset:776
    ds_read_b64_tr_b16 a[16:17], v10 offset:6152
    ds_read_b64_tr_b16 a[18:19], v10 offset:6920
    ds_read_b64_tr_b16 a[28:29], v10 offset:12296
    ds_read_b64_tr_b16 a[30:31], v10 offset:13064
    ds_read_b128 v[28:31], v8 offset:0
    ds_read_b64_tr_b16 a[8:9], v12 offset:0
    ds_read_b64_tr_b16 a[10:11], v12 offset:768
    ds_read_b64_tr_b16 a[20:21], v12 offset:6144
    ds_read_b64_tr_b16 a[22:23], v12 offset:6912
    ds_read_b64_tr_b16 a[32:33], v12 offset:12288
    ds_read_b64_tr_b16 a[34:35], v12 offset:13056
    s_waitcnt lgkmcnt(15)
    s_waitcnt lgkmcnt(13)
    v_mfma_f32_16x16x32_bf16 v[48:51], a[0:3], v[16:19], 0
    s_add_u32 m0, s27, 21504
    s_add_u32 s25, s25, s44
    v_mfma_f32_16x16x32_bf16 v[48:51], a[12:15], v[20:23], v[48:51]
    buffer_load_dwordx4 v3, s[4:7], s26 offen nt lds
    v_mfma_f32_16x16x32_bf16 v[48:51], a[24:27], v[24:27], v[48:51]
    s_add_u32 m0, s27, 22528
    s_nop 0
    buffer_load_dwordx4 v4, s[4:7], s26 offen nt lds
    s_waitcnt vmcnt(8)
    s_barrier
    s_waitcnt lgkmcnt(7)
    v_mfma_f32_16x16x32_bf16 v[52:55], a[28:31], v[24:27], 0
    ds_read_b128 v[32:35], v9 offset:3072
    s_add_u32 m0, s27, 23552
    v_mfma_f32_16x16x32_bf16 v[52:55], a[16:19], v[20:23], v[52:55]
    buffer_load_dwordx4 v5, s[4:7], s26 offen nt lds
    v_mfma_f32_16x16x32_bf16 v[52:55], a[4:7], v[16:19], v[52:55]
    s_add_u32 m0, s27, 24576
    ds_read_b64_tr_b16 a[36:37], v10 offset:18432
    s_waitcnt lgkmcnt(2)
    v_mfma_f32_16x16x32_bf16 v[56:59], a[8:11], v[16:19], 0
    ds_read_b64_tr_b16 a[38:39], v10 offset:19200
    ds_read_b64_tr_b16 a[48:49], v10 offset:24576
    v_mfma_f32_16x16x32_bf16 v[56:59], a[20:23], v[20:23], v[56:59]
    buffer_load_dwordx4 v6, s[4:7], s26 offen nt lds
    v_mfma_f32_16x16x32_bf16 v[56:59], a[32:35], v[24:27], v[56:59]
    ds_read_b64_tr_b16 a[50:51], v10 offset:25344
    v_mfma_f32_16x16x32_bf16 v[68:71], a[32:35], v[28:31], 0
    s_add_u32 m0, s28, 57344
    s_mov_b32 s29, 57344
    v_mfma_f32_16x16x32_bf16 v[68:71], a[20:23], v[24:27], v[68:71]
    buffer_load_dwordx4 v14, s[8:11], s29 offen lds
    v_mfma_f32_16x16x32_bf16 v[68:71], a[8:11], v[20:23], v[68:71]
    ds_read_b64_tr_b16 a[60:61], v10 offset:30720
    ds_read_b64_tr_b16 a[62:63], v10 offset:31488
    v_mfma_f32_16x16x32_bf16 v[64:67], a[4:7], v[20:23], 0
    ds_read_b128 v[36:39], v7 offset:256
    ds_read_b64_tr_b16 a[40:41], v10 offset:18440
    v_mfma_f32_16x16x32_bf16 v[64:67], a[16:19], v[24:27], v[64:67]
    ds_read_b128 v[40:43], v8 offset:3328
    ds_read_b64_tr_b16 a[42:43], v10 offset:19208
    v_mfma_f32_16x16x32_bf16 v[64:67], a[28:31], v[28:31], v[64:67]
    ds_read_b128 v[44:47], v9 offset:6400
    s_add_u32 m0, s28, 61440
    v_mfma_f32_16x16x32_bf16 v[60:63], a[24:27], v[28:31], 0
    ds_read_b128 v[192:195], v8 offset:256
    s_mov_b32 s29, 73728
    v_mfma_f32_16x16x32_bf16 v[60:63], a[12:15], v[24:27], v[60:63]
    buffer_load_dwordx4 v14, s[8:11], s29 offen lds
    v_mfma_f32_16x16x32_bf16 v[60:63], a[0:3], v[20:23], v[60:63]
    ds_read_b64_tr_b16 a[52:53], v10 offset:24584
    s_waitcnt lgkmcnt(13)
    v_mfma_f32_16x16x32_bf16 v[72:75], a[0:3], v[24:27], 0
    ds_read_b128 v[196:199], v9 offset:3328
    ds_read_b64_tr_b16 a[54:55], v10 offset:25352
    v_mfma_f32_16x16x32_bf16 v[72:75], a[12:15], v[28:31], v[72:75]
    s_add_u32 m0, s28, 65536
    s_add_u32 s29, s46, 77824
    v_mfma_f32_16x16x32_bf16 v[72:75], a[24:27], v[32:35], v[72:75]
    ds_read_b64_tr_b16 a[64:65], v10 offset:30728
    ds_read_b64_tr_b16 a[66:67], v10 offset:31496
    v_mfma_f32_16x16x32_bf16 v[76:79], a[28:31], v[32:35], 0
    ds_read_b64_tr_b16 a[44:45], v12 offset:18432
    ds_read_b64_tr_b16 a[46:47], v12 offset:19200
    v_mfma_f32_16x16x32_bf16 v[76:79], a[16:19], v[28:31], v[76:79]
    buffer_load_dwordx4 v14, s[8:11], s29 offen lds
    v_mfma_f32_16x16x32_bf16 v[76:79], a[4:7], v[24:27], v[76:79]
    ds_read_b64_tr_b16 a[56:57], v12 offset:24576
    ds_read_b64_tr_b16 a[58:59], v12 offset:25344
    v_mfma_f32_16x16x32_bf16 v[80:83], a[8:11], v[24:27], 0
    s_add_u32 m0, s28, 69632
    s_mov_b32 s29, 94208
    v_mfma_f32_16x16x32_bf16 v[80:83], a[20:23], v[28:31], v[80:83]
    buffer_load_dwordx4 v14, s[8:11], s29 offen lds
    v_mfma_f32_16x16x32_bf16 v[80:83], a[32:35], v[32:35], v[80:83]
    ds_read_b64_tr_b16 a[68:69], v12 offset:30720
    s_waitcnt vmcnt(9)
    s_barrier
    ds_read_b64_tr_b16 a[70:71], v12 offset:31488
    s_waitcnt lgkmcnt(0)
    v_mfma_f32_16x16x32_bf16 v[48:51], a[36:39], v[36:39], v[48:51]
    ds_read_b64_tr_b16 a[72:73], v11 offset:0
    ds_read_b64_tr_b16 a[74:75], v11 offset:768
    v_mfma_f32_16x16x32_bf16 v[48:51], a[48:51], v[40:43], v[48:51]
    ds_read_b64_tr_b16 a[84:85], v11 offset:6144
    ds_read_b64_tr_b16 a[86:87], v11 offset:6912
    v_mfma_f32_16x16x32_bf16 v[48:51], a[60:63], v[44:47], v[48:51]
    ds_read_b64_tr_b16 a[96:97], v11 offset:12288
    ds_read_b64_tr_b16 a[98:99], v11 offset:13056
    v_mfma_f32_16x16x32_bf16 v[60:63], a[60:63], v[192:195], v[60:63]
    ds_read_b64_tr_b16 a[76:77], v11 offset:8
    ds_read_b64_tr_b16 a[78:79], v11 offset:776
    v_mfma_f32_16x16x32_bf16 v[60:63], a[48:51], v[44:47], v[60:63]
    s_add_u32 m0, s27, 40960
    s_mov_b32 s26, s25
    v_mfma_f32_16x16x32_bf16 v[60:63], a[36:39], v[40:43], v[60:63]
    ds_read_b64_tr_b16 a[88:89], v11 offset:6152
    v_mfma_f32_16x16x32_bf16 v[72:75], a[36:39], v[44:47], v[72:75]
    ds_read_b64_tr_b16 a[90:91], v11 offset:6920
    ds_read_b64_tr_b16 a[100:101], v11 offset:12296
    v_mfma_f32_16x16x32_bf16 v[72:75], a[48:51], v[192:195], v[72:75]
    buffer_load_dwordx4 v2, s[4:7], s26 offen nt lds
    v_mfma_f32_16x16x32_bf16 v[72:75], a[60:63], v[196:199], v[72:75]
    ds_read_b64_tr_b16 a[102:103], v11 offset:13064
    ds_read_b64_tr_b16 a[80:81], v13 offset:0
    v_mfma_f32_16x16x32_bf16 v[76:79], a[64:67], v[196:199], v[76:79]
    ds_read_b64_tr_b16 a[82:83], v13 offset:768
    ds_read_b64_tr_b16 a[92:93], v13 offset:6144
    v_mfma_f32_16x16x32_bf16 v[76:79], a[52:55], v[192:195], v[76:79]
    ds_read_b64_tr_b16 a[94:95], v13 offset:6912
    ds_read_b64_tr_b16 a[104:105], v13 offset:12288
    v_mfma_f32_16x16x32_bf16 v[76:79], a[40:43], v[44:47], v[76:79]
    ds_read_b64_tr_b16 a[106:107], v13 offset:13056
    v_mfma_f32_16x16x32_bf16 v[64:67], a[40:43], v[40:43], v[64:67]
    ds_read_b128 v[200:203], v7 offset:512
    s_add_u32 m0, s27, 41984
    v_mfma_f32_16x16x32_bf16 v[64:67], a[52:55], v[44:47], v[64:67]
    ds_read_b128 v[16:19], v8 offset:3584
    s_add_u32 s25, s25, s44
    v_mfma_f32_16x16x32_bf16 v[64:67], a[64:67], v[192:195], v[64:67]
    ds_read_b128 v[20:23], v9 offset:6656
    v_mfma_f32_16x16x32_bf16 v[52:55], a[64:67], v[44:47], v[52:55]
    ds_read_b128 v[24:27], v8 offset:512
    v_mfma_f32_16x16x32_bf16 v[52:55], a[52:55], v[40:43], v[52:55]
    buffer_load_dwordx4 v3, s[4:7], s26 offen nt lds
    v_mfma_f32_16x16x32_bf16 v[52:55], a[40:43], v[36:39], v[52:55]
    v_mfma_f32_16x16x32_bf16 v[56:59], a[44:47], v[36:39], v[56:59]
    ds_read_b128 v[28:31], v9 offset:3584
    v_mfma_f32_16x16x32_bf16 v[56:59], a[56:59], v[40:43], v[56:59]
    v_mfma_f32_16x16x32_bf16 v[56:59], a[68:71], v[44:47], v[56:59]
    s_add_u32 m0, s27, 43008
    v_mfma_f32_16x16x32_bf16 v[68:71], a[68:71], v[192:195], v[68:71]
    v_mfma_f32_16x16x32_bf16 v[68:71], a[56:59], v[44:47], v[68:71]
    buffer_load_dwordx4 v4, s[4:7], s26 offen nt lds
    v_mfma_f32_16x16x32_bf16 v[68:71], a[44:47], v[40:43], v[68:71]
    v_mfma_f32_16x16x32_bf16 v[80:83], a[44:47], v[44:47], v[80:83]
    v_mfma_f32_16x16x32_bf16 v[80:83], a[56:59], v[192:195], v[80:83]
    v_mfma_f32_16x16x32_bf16 v[80:83], a[68:71], v[196:199], v[80:83]
    s_waitcnt lgkmcnt(5)
    s_waitcnt lgkmcnt(1)
    v_mfma_f32_16x16x32_bf16 v[48:51], a[72:75], v[200:203], v[48:51]
    v_mfma_f32_16x16x32_bf16 v[48:51], a[84:87], v[16:19], v[48:51]
    s_add_u32 m0, s27, 44032
    v_mfma_f32_16x16x32_bf16 v[48:51], a[96:99], v[20:23], v[48:51]
    v_mfma_f32_16x16x32_bf16 v[60:63], a[96:99], v[24:27], v[60:63]
    v_mfma_f32_16x16x32_bf16 v[60:63], a[84:87], v[20:23], v[60:63]
    buffer_load_dwordx4 v5, s[4:7], s26 offen nt lds
    v_mfma_f32_16x16x32_bf16 v[60:63], a[72:75], v[16:19], v[60:63]
    s_waitcnt lgkmcnt(0)
    v_mfma_f32_16x16x32_bf16 v[72:75], a[72:75], v[20:23], v[72:75]
    v_mfma_f32_16x16x32_bf16 v[72:75], a[84:87], v[24:27], v[72:75]
    v_mfma_f32_16x16x32_bf16 v[72:75], a[96:99], v[28:31], v[72:75]
    v_mfma_f32_16x16x32_bf16 v[76:79], a[100:103], v[28:31], v[76:79]
    s_add_u32 m0, s27, 45056
    v_mfma_f32_16x16x32_bf16 v[76:79], a[88:91], v[24:27], v[76:79]
    buffer_load_dwordx4 v6, s[4:7], s26 offen nt lds
    v_mfma_f32_16x16x32_bf16 v[76:79], a[76:79], v[20:23], v[76:79]
    s_waitcnt vmcnt(9)
    s_barrier
    v_mfma_f32_16x16x32_bf16 v[64:67], a[76:79], v[16:19], v[64:67]
    ds_read_b128 v[32:35], v7 offset:20480
    v_mfma_f32_16x16x32_bf16 v[64:67], a[88:91], v[20:23], v[64:67]
    ds_read_b128 v[36:39], v8 offset:23552
    v_mfma_f32_16x16x32_bf16 v[64:67], a[100:103], v[24:27], v[64:67]
    ds_read_b128 v[40:43], v9 offset:26624
    v_mfma_f32_16x16x32_bf16 v[52:55], a[100:103], v[20:23], v[52:55]
    v_mfma_f32_16x16x32_bf16 v[52:55], a[88:91], v[16:19], v[52:55]
    v_mfma_f32_16x16x32_bf16 v[52:55], a[76:79], v[200:203], v[52:55]
    v_mfma_f32_16x16x32_bf16 v[56:59], a[80:83], v[200:203], v[56:59]
    v_mfma_f32_16x16x32_bf16 v[56:59], a[92:95], v[16:19], v[56:59]
    v_mfma_f32_16x16x32_bf16 v[56:59], a[104:107], v[20:23], v[56:59]
    v_mfma_f32_16x16x32_bf16 v[68:71], a[104:107], v[24:27], v[68:71]
    ds_read_b128 v[44:47], v8 offset:20480
    v_mfma_f32_16x16x32_bf16 v[68:71], a[92:95], v[20:23], v[68:71]
    v_mfma_f32_16x16x32_bf16 v[68:71], a[80:83], v[16:19], v[68:71]
    v_mfma_f32_16x16x32_bf16 v[80:83], a[80:83], v[20:23], v[80:83]
    v_mfma_f32_16x16x32_bf16 v[80:83], a[92:95], v[24:27], v[80:83]
    v_mfma_f32_16x16x32_bf16 v[80:83], a[104:107], v[28:31], v[80:83]
    s_add_u32 m0, s28, 0
    s_waitcnt lgkmcnt(1)
    v_mfma_f32_16x16x32_bf16 v[84:87], a[0:3], v[32:35], 0
    s_mov_b32 s29, 61440
    v_mfma_f32_16x16x32_bf16 v[84:87], a[12:15], v[36:39], v[84:87]
    buffer_load_dwordx4 v14, s[8:11], s29 offen lds
    v_mfma_f32_16x16x32_bf16 v[84:87], a[24:27], v[40:43], v[84:87]
    v_mfma_f32_16x16x32_bf16 v[88:91], a[28:31], v[40:43], 0
    ds_read_b128 v[192:195], v9 offset:23552
    v_mfma_f32_16x16x32_bf16 v[88:91], a[16:19], v[36:39], v[88:91]
    v_mfma_f32_16x16x32_bf16 v[88:91], a[4:7], v[32:35], v[88:91]
    v_mfma_f32_16x16x32_bf16 v[92:95], a[8:11], v[32:35], 0
    v_mfma_f32_16x16x32_bf16 v[92:95], a[20:23], v[36:39], v[92:95]
    v_mfma_f32_16x16x32_bf16 v[92:95], a[32:35], v[40:43], v[92:95]
    s_waitcnt lgkmcnt(1)
    v_mfma_f32_16x16x32_bf16 v[104:107], a[32:35], v[44:47], 0
    v_mfma_f32_16x16x32_bf16 v[104:107], a[20:23], v[40:43], v[104:107]
    v_mfma_f32_16x16x32_bf16 v[104:107], a[8:11], v[36:39], v[104:107]
    v_mfma_f32_16x16x32_bf16 v[100:103], a[4:7], v[36:39], 0
    ds_read_b128 v[196:199], v7 offset:20736
    v_mfma_f32_16x16x32_bf16 v[100:103], a[16:19], v[40:43], v[100:103]
    ds_read_b128 v[200:203], v8 offset:23808
    v_mfma_f32_16x16x32_bf16 v[100:103], a[28:31], v[44:47], v[100:103]
    ds_read_b128 v[16:19], v9 offset:26880
    v_mfma_f32_16x16x32_bf16 v[96:99], a[24:27], v[44:47], 0
    ds_read_b128 v[20:23], v8 offset:20736
    v_mfma_f32_16x16x32_bf16 v[96:99], a[12:15], v[40:43], v[96:99]
    s_add_u32 m0, s28, 4096
    s_add_u32 s29, s46, 65536
    v_mfma_f32_16x16x32_bf16 v[96:99], a[0:3], v[36:39], v[96:99]
    s_waitcnt lgkmcnt(4)
    v_mfma_f32_16x16x32_bf16 v[108:111], a[0:3], v[40:43], 0
    ds_read_b128 v[24:27], v9 offset:23808
    v_mfma_f32_16x16x32_bf16 v[108:111], a[12:15], v[44:47], v[108:111]
    buffer_load_dwordx4 v14, s[8:11], s29 offen lds
    v_mfma_f32_16x16x32_bf16 v[108:111], a[24:27], v[192:195], v[108:111]
    v_mfma_f32_16x16x32_bf16 v[112:115], a[28:31], v[192:195], 0
    v_mfma_f32_16x16x32_bf16 v[112:115], a[16:19], v[44:47], v[112:115]
    v_mfma_f32_16x16x32_bf16 v[112:115], a[4:7], v[40:43], v[112:115]
    v_mfma_f32_16x16x32_bf16 v[116:119], a[8:11], v[40:43], 0
    v_mfma_f32_16x16x32_bf16 v[116:119], a[20:23], v[44:47], v[116:119]
    v_mfma_f32_16x16x32_bf16 v[116:119], a[32:35], v[192:195], v[116:119]
    s_waitcnt lgkmcnt(1)
    v_mfma_f32_16x16x32_bf16 v[84:87], a[36:39], v[196:199], v[84:87]
    v_mfma_f32_16x16x32_bf16 v[84:87], a[48:51], v[200:203], v[84:87]
    v_mfma_f32_16x16x32_bf16 v[84:87], a[60:63], v[16:19], v[84:87]
    v_mfma_f32_16x16x32_bf16 v[96:99], a[60:63], v[20:23], v[96:99]
    v_mfma_f32_16x16x32_bf16 v[96:99], a[48:51], v[16:19], v[96:99]
    v_mfma_f32_16x16x32_bf16 v[96:99], a[36:39], v[200:203], v[96:99]
    s_waitcnt lgkmcnt(0)
    v_mfma_f32_16x16x32_bf16 v[108:111], a[36:39], v[16:19], v[108:111]
    s_add_u32 m0, s28, 8192
    s_mov_b32 s29, 81920
    v_mfma_f32_16x16x32_bf16 v[108:111], a[48:51], v[20:23], v[108:111]
    buffer_load_dwordx4 v14, s[8:11], s29 offen lds
    v_mfma_f32_16x16x32_bf16 v[108:111], a[60:63], v[24:27], v[108:111]
    v_mfma_f32_16x16x32_bf16 v[112:115], a[64:67], v[24:27], v[112:115]
    v_mfma_f32_16x16x32_bf16 v[112:115], a[52:55], v[20:23], v[112:115]
    v_mfma_f32_16x16x32_bf16 v[112:115], a[40:43], v[16:19], v[112:115]
    v_mfma_f32_16x16x32_bf16 v[100:103], a[40:43], v[200:203], v[100:103]
    ds_read_b128 v[28:31], v7 offset:20992
    v_mfma_f32_16x16x32_bf16 v[100:103], a[52:55], v[16:19], v[100:103]
    ds_read_b128 v[32:35], v8 offset:24064
    v_mfma_f32_16x16x32_bf16 v[100:103], a[64:67], v[20:23], v[100:103]
    ds_read_b128 v[36:39], v9 offset:27136
    v_mfma_f32_16x16x32_bf16 v[88:91], a[64:67], v[16:19], v[88:91]
    ds_read_b128 v[40:43], v8 offset:20992
    v_mfma_f32_16x16x32_bf16 v[88:91], a[52:55], v[200:203], v[88:91]
    v_mfma_f32_16x16x32_bf16 v[88:91], a[40:43], v[196:199], v[88:91]
    v_mfma_f32_16x16x32_bf16 v[92:95], a[44:47], v[196:199], v[92:95]
    ds_read_b128 v[44:47], v9 offset:24064
    v_mfma_f32_16x16x32_bf16 v[92:95], a[56:59], v[200:203], v[92:95]
    v_mfma_f32_16x16x32_bf16 v[92:95], a[68:71], v[16:19], v[92:95]
    v_mfma_f32_16x16x32_bf16 v[104:107], a[68:71], v[20:23], v[104:107]
    v_mfma_f32_16x16x32_bf16 v[104:107], a[56:59], v[16:19], v[104:107]
    v_mfma_f32_16x16x32_bf16 v[104:107], a[44:47], v[200:203], v[104:107]
    v_mfma_f32_16x16x32_bf16 v[116:119], a[44:47], v[16:19], v[116:119]
    s_add_u32 m0, s28, 12288
    s_mov_b32 s29, 98304
    v_mfma_f32_16x16x32_bf16 v[116:119], a[56:59], v[20:23], v[116:119]
    buffer_load_dwordx4 v14, s[8:11], s29 offen lds
    v_mfma_f32_16x16x32_bf16 v[116:119], a[68:71], v[24:27], v[116:119]
    s_waitcnt vmcnt(9)
    s_barrier
    s_waitcnt lgkmcnt(1)
    v_mfma_f32_16x16x32_bf16 v[84:87], a[72:75], v[28:31], v[84:87]
    ds_read_b64_tr_b16 a[108:109], v11 offset:18432
    ds_read_b64_tr_b16 a[110:111], v11 offset:19200
    v_mfma_f32_16x16x32_bf16 v[84:87], a[84:87], v[32:35], v[84:87]
    ds_read_b64_tr_b16 a[120:121], v11 offset:24576
    ds_read_b64_tr_b16 a[122:123], v11 offset:25344
    v_mfma_f32_16x16x32_bf16 v[84:87], a[96:99], v[36:39], v[84:87]
    ds_read_b64_tr_b16 a[132:133], v11 offset:30720
    ds_read_b64_tr_b16 a[134:135], v11 offset:31488
    v_mfma_f32_16x16x32_bf16 v[96:99], a[96:99], v[40:43], v[96:99]
    ds_read_b64_tr_b16 a[112:113], v11 offset:18440
    ds_read_b64_tr_b16 a[114:115], v11 offset:19208
    v_mfma_f32_16x16x32_bf16 v[96:99], a[84:87], v[36:39], v[96:99]
    s_add_u32 m0, s28, 16384
    s_add_u32 s29, s49, 102400
    v_mfma_f32_16x16x32_bf16 v[96:99], a[72:75], v[32:35], v[96:99]
    ds_read_b64_tr_b16 a[124:125], v11 offset:24584
    s_waitcnt lgkmcnt(9)
    v_mfma_f32_16x16x32_bf16 v[108:111], a[72:75], v[36:39], v[108:111]
    ds_read_b64_tr_b16 a[126:127], v11 offset:25352
    ds_read_b64_tr_b16 a[136:137], v11 offset:30728
    v_mfma_f32_16x16x32_bf16 v[108:111], a[84:87], v[40:43], v[108:111]
    buffer_load_dwordx4 v14, s[8:11], s29 offen lds
    v_mfma_f32_16x16x32_bf16 v[108:111], a[96:99], v[44:47], v[108:111]
    ds_read_b64_tr_b16 a[138:139], v11 offset:31496
    ds_read_b64_tr_b16 a[116:117], v13 offset:18432
    v_mfma_f32_16x16x32_bf16 v[112:115], a[100:103], v[44:47], v[112:115]
    ds_read_b64_tr_b16 a[118:119], v13 offset:19200
    ds_read_b64_tr_b16 a[128:129], v13 offset:24576
    v_mfma_f32_16x16x32_bf16 v[112:115], a[88:91], v[40:43], v[112:115]
    ds_read_b64_tr_b16 a[130:131], v13 offset:25344
    ds_read_b64_tr_b16 a[140:141], v13 offset:30720
    v_mfma_f32_16x16x32_bf16 v[112:115], a[76:79], v[36:39], v[112:115]
    ds_read_b64_tr_b16 a[142:143], v13 offset:31488
    v_mfma_f32_16x16x32_bf16 v[100:103], a[76:79], v[32:35], v[100:103]
    ds_read_b128 v[192:195], v7 offset:10240
    s_add_u32 m0, s28, 20480
    v_mfma_f32_16x16x32_bf16 v[100:103], a[88:91], v[36:39], v[100:103]
    ds_read_b128 v[196:199], v8 offset:13312
    s_mov_b32 s29, 69632
    v_mfma_f32_16x16x32_bf16 v[100:103], a[100:103], v[40:43], v[100:103]
    ds_read_b128 v[200:203], v9 offset:16384
    v_mfma_f32_16x16x32_bf16 v[88:91], a[100:103], v[36:39], v[88:91]
    ds_read_b128 v[16:19], v8 offset:10240
    v_mfma_f32_16x16x32_bf16 v[88:91], a[88:91], v[32:35], v[88:91]
    buffer_load_dwordx4 v14, s[8:11], s29 offen lds
    v_mfma_f32_16x16x32_bf16 v[88:91], a[76:79], v[28:31], v[88:91]
    v_mfma_f32_16x16x32_bf16 v[92:95], a[80:83], v[28:31], v[92:95]
    ds_read_b128 v[20:23], v9 offset:13312
    v_mfma_f32_16x16x32_bf16 v[92:95], a[92:95], v[32:35], v[92:95]
    v_mfma_f32_16x16x32_bf16 v[92:95], a[104:107], v[36:39], v[92:95]
    s_add_u32 m0, s28, 24576
    s_mov_b32 s29, 86016
    v_mfma_f32_16x16x32_bf16 v[104:107], a[104:107], v[40:43], v[104:107]
    v_mfma_f32_16x16x32_bf16 v[104:107], a[92:95], v[36:39], v[104:107]
    buffer_load_dwordx4 v14, s[8:11], s29 offen lds
    v_mfma_f32_16x16x32_bf16 v[104:107], a[80:83], v[32:35], v[104:107]
    v_mfma_f32_16x16x32_bf16 v[116:119], a[80:83], v[36:39], v[116:119]
    v_mfma_f32_16x16x32_bf16 v[116:119], a[92:95], v[40:43], v[116:119]
    v_mfma_f32_16x16x32_bf16 v[116:119], a[104:107], v[44:47], v[116:119]
    s_waitcnt lgkmcnt(5)
    s_waitcnt lgkmcnt(1)
    v_mfma_f32_16x16x32_bf16 v[48:51], a[108:111], v[192:195], v[48:51]
    v_mfma_f32_16x16x32_bf16 v[48:51], a[120:123], v[196:199], v[48:51]
    s_add_u32 m0, s28, 28672
    s_add_u32 s29, s46, 90112
    v_mfma_f32_16x16x32_bf16 v[48:51], a[132:135], v[200:203], v[48:51]
    v_mfma_f32_16x16x32_bf16 v[60:63], a[132:135], v[16:19], v[60:63]
    v_mfma_f32_16x16x32_bf16 v[60:63], a[120:123], v[200:203], v[60:63]
    buffer_load_dwordx4 v14, s[8:11], s29 offen lds
    v_mfma_f32_16x16x32_bf16 v[60:63], a[108:111], v[196:199], v[60:63]
    s_waitcnt lgkmcnt(0)
    v_mfma_f32_16x16x32_bf16 v[72:75], a[108:111], v[200:203], v[72:75]
    v_mfma_f32_16x16x32_bf16 v[72:75], a[120:123], v[16:19], v[72:75]
    v_mfma_f32_16x16x32_bf16 v[72:75], a[132:135], v[20:23], v[72:75]
    v_mfma_f32_16x16x32_bf16 v[76:79], a[136:139], v[20:23], v[76:79]
    s_add_u32 m0, s28, 32768
    s_mov_b32 s29, 106496
    v_mfma_f32_16x16x32_bf16 v[76:79], a[124:127], v[16:19], v[76:79]
    buffer_load_dwordx4 v14, s[8:11], s29 offen lds
    v_mfma_f32_16x16x32_bf16 v[76:79], a[112:115], v[200:203], v[76:79]
    s_waitcnt vmcnt(9)
    s_barrier
    v_mfma_f32_16x16x32_bf16 v[64:67], a[112:115], v[196:199], v[64:67]
    ds_read_b128 v[24:27], v7 offset:30720
    s_add_u32 m0, s28, 36864
    v_mfma_f32_16x16x32_bf16 v[64:67], a[124:127], v[200:203], v[64:67]
    ds_read_b128 v[28:31], v8 offset:33792
    s_add_u32 s29, s42, 110592
    v_mfma_f32_16x16x32_bf16 v[64:67], a[136:139], v[16:19], v[64:67]
    ds_read_b128 v[32:35], v9 offset:36864
    v_mfma_f32_16x16x32_bf16 v[52:55], a[136:139], v[200:203], v[52:55]
    ds_read_b128 v[36:39], v8 offset:30720
    v_mfma_f32_16x16x32_bf16 v[52:55], a[124:127], v[196:199], v[52:55]
    buffer_load_dwordx4 v14, s[8:11], s29 offen lds
    v_mfma_f32_16x16x32_bf16 v[52:55], a[112:115], v[192:195], v[52:55]
    s_add_u32 m0, s28, 40960
    s_add_u32 s29, s47, 114688
    v_mfma_f32_16x16x32_bf16 v[56:59], a[116:119], v[192:195], v[56:59]
    ds_read_b128 v[40:43], v9 offset:33792
    v_mfma_f32_16x16x32_bf16 v[56:59], a[128:131], v[196:199], v[56:59]
    buffer_load_dwordx4 v14, s[8:11], s29 offen lds
    v_mfma_f32_16x16x32_bf16 v[56:59], a[140:143], v[200:203], v[56:59]
    s_add_u32 m0, s28, 45056
    s_add_u32 s29, s42, 131072
    v_mfma_f32_16x16x32_bf16 v[68:71], a[140:143], v[16:19], v[68:71]
    v_mfma_f32_16x16x32_bf16 v[68:71], a[128:131], v[200:203], v[68:71]
    buffer_load_dwordx4 v14, s[8:11], s29 offen lds
    v_mfma_f32_16x16x32_bf16 v[68:71], a[116:119], v[196:199], v[68:71]
    s_add_u32 m0, s28, 49152
    s_add_u32 s29, s42, 147456
    v_mfma_f32_16x16x32_bf16 v[80:83], a[116:119], v[200:203], v[80:83]
    v_mfma_f32_16x16x32_bf16 v[80:83], a[128:131], v[16:19], v[80:83]
    buffer_load_dwordx4 v14, s[8:11], s29 offen lds
    v_mfma_f32_16x16x32_bf16 v[80:83], a[140:143], v[20:23], v[80:83]
    s_add_u32 m0, s28, 53248
    s_add_u32 s29, s50, 151552
    buffer_load_dwordx4 v14, s[8:11], s29 offen lds
    s_waitcnt vmcnt(9)
    s_barrier
    s_waitcnt lgkmcnt(1)
    v_mfma_f32_16x16x32_bf16 v[84:87], a[108:111], v[24:27], v[84:87]
    ds_read_b64_tr_b16 a[144:145], v10 offset:0
    ds_read_b64_tr_b16 a[146:147], v10 offset:768
    v_mfma_f32_16x16x32_bf16 v[84:87], a[120:123], v[28:31], v[84:87]
    ds_read_b64_tr_b16 a[156:157], v10 offset:6144
    ds_read_b64_tr_b16 a[158:159], v10 offset:6912
    v_mfma_f32_16x16x32_bf16 v[84:87], a[132:135], v[32:35], v[84:87]
    ds_read_b64_tr_b16 a[168:169], v10 offset:12288
    ds_read_b64_tr_b16 a[170:171], v10 offset:13056
    v_mfma_f32_16x16x32_bf16 v[96:99], a[132:135], v[36:39], v[96:99]
    ds_read_b64_tr_b16 a[148:149], v10 offset:8
    ds_read_b64_tr_b16 a[150:151], v10 offset:776
    v_mfma_f32_16x16x32_bf16 v[96:99], a[120:123], v[32:35], v[96:99]
    ds_read_b64_tr_b16 a[160:161], v10 offset:6152
    ds_read_b64_tr_b16 a[162:163], v10 offset:6920
    v_mfma_f32_16x16x32_bf16 v[96:99], a[108:111], v[28:31], v[96:99]
    ds_read_b64_tr_b16 a[172:173], v10 offset:12296
    s_waitcnt lgkmcnt(11)
    v_mfma_f32_16x16x32_bf16 v[108:111], a[108:111], v[32:35], v[108:111]
    ds_read_b64_tr_b16 a[174:175], v10 offset:13064
    ds_read_b64_tr_b16 a[152:153], v12 offset:0
    v_mfma_f32_16x16x32_bf16 v[108:111], a[120:123], v[36:39], v[108:111]
    ds_read_b64_tr_b16 a[154:155], v12 offset:768
    ds_read_b64_tr_b16 a[164:165], v12 offset:6144
    v_mfma_f32_16x16x32_bf16 v[108:111], a[132:135], v[40:43], v[108:111]
    ds_read_b64_tr_b16 a[166:167], v12 offset:6912
    ds_read_b64_tr_b16 a[176:177], v12 offset:12288
    v_mfma_f32_16x16x32_bf16 v[112:115], a[136:139], v[40:43], v[112:115]
    ds_read_b64_tr_b16 a[178:179], v12 offset:13056
    v_mfma_f32_16x16x32_bf16 v[112:115], a[124:127], v[36:39], v[112:115]
    s_add_u32 m0, s28, 57344
    s_add_u32 s29, s42, 118784
    v_mfma_f32_16x16x32_bf16 v[112:115], a[112:115], v[32:35], v[112:115]
    v_mfma_f32_16x16x32_bf16 v[100:103], a[112:115], v[28:31], v[100:103]
    ds_read_b128 v[44:47], v7 offset:10496
    v_mfma_f32_16x16x32_bf16 v[100:103], a[124:127], v[32:35], v[100:103]
    ds_read_b128 v[192:195], v8 offset:13568
    v_mfma_f32_16x16x32_bf16 v[100:103], a[136:139], v[36:39], v[100:103]
    ds_read_b128 v[196:199], v9 offset:16640
    v_mfma_f32_16x16x32_bf16 v[88:91], a[136:139], v[32:35], v[88:91]
    ds_read_b128 v[200:203], v8 offset:10496
    v_mfma_f32_16x16x32_bf16 v[88:91], a[124:127], v[28:31], v[88:91]
    buffer_load_dwordx4 v14, s[8:11], s29 offen lds
    v_mfma_f32_16x16x32_bf16 v[88:91], a[112:115], v[24:27], v[88:91]
    v_mfma_f32_16x16x32_bf16 v[92:95], a[116:119], v[24:27], v[92:95]
    ds_read_b128 v[16:19], v9 offset:13568
    v_mfma_f32_16x16x32_bf16 v[92:95], a[128:131], v[28:31], v[92:95]
    v_mfma_f32_16x16x32_bf16 v[92:95], a[140:143], v[32:35], v[92:95]
    v_mfma_f32_16x16x32_bf16 v[104:107], a[140:143], v[36:39], v[104:107]
    v_mfma_f32_16x16x32_bf16 v[104:107], a[128:131], v[32:35], v[104:107]
    v_mfma_f32_16x16x32_bf16 v[104:107], a[116:119], v[28:31], v[104:107]
    v_mfma_f32_16x16x32_bf16 v[116:119], a[116:119], v[32:35], v[116:119]
    s_add_u32 m0, s28, 61440
    s_add_u32 s29, s42, 135168
    v_mfma_f32_16x16x32_bf16 v[116:119], a[128:131], v[36:39], v[116:119]
    buffer_load_dwordx4 v14, s[8:11], s29 offen lds
    v_mfma_f32_16x16x32_bf16 v[116:119], a[140:143], v[40:43], v[116:119]
    s_waitcnt lgkmcnt(5)
    s_waitcnt lgkmcnt(1)
    v_mfma_f32_16x16x32_bf16 v[48:51], a[144:147], v[44:47], v[48:51]
    v_mfma_f32_16x16x32_bf16 v[48:51], a[156:159], v[192:195], v[48:51]
    v_mfma_f32_16x16x32_bf16 v[48:51], a[168:171], v[196:199], v[48:51]
    v_mfma_f32_16x16x32_bf16 v[60:63], a[168:171], v[200:203], v[60:63]
    v_mfma_f32_16x16x32_bf16 v[60:63], a[156:159], v[196:199], v[60:63]
    v_mfma_f32_16x16x32_bf16 v[60:63], a[144:147], v[192:195], v[60:63]
    s_waitcnt lgkmcnt(0)
    v_mfma_f32_16x16x32_bf16 v[72:75], a[144:147], v[196:199], v[72:75]
    v_mfma_f32_16x16x32_bf16 v[72:75], a[156:159], v[200:203], v[72:75]
    v_mfma_f32_16x16x32_bf16 v[72:75], a[168:171], v[16:19], v[72:75]
    v_mfma_f32_16x16x32_bf16 v[76:79], a[172:175], v[16:19], v[76:79]
    v_mfma_f32_16x16x32_bf16 v[76:79], a[160:163], v[200:203], v[76:79]
    s_add_u32 m0, s28, 65536
    s_add_u32 s29, s47, 139264
    v_mfma_f32_16x16x32_bf16 v[76:79], a[148:151], v[196:199], v[76:79]
    v_mfma_f32_16x16x32_bf16 v[64:67], a[148:151], v[192:195], v[64:67]
    ds_read_b128 v[20:23], v7 offset:30976
    v_mfma_f32_16x16x32_bf16 v[64:67], a[160:163], v[196:199], v[64:67]
    ds_read_b128 v[24:27], v8 offset:34048
    v_mfma_f32_16x16x32_bf16 v[64:67], a[172:175], v[200:203], v[64:67]
    ds_read_b128 v[28:31], v9 offset:37120
    v_mfma_f32_16x16x32_bf16 v[52:55], a[172:175], v[196:199], v[52:55]
    ds_read_b128 v[32:35], v8 offset:30976
    v_mfma_f32_16x16x32_bf16 v[52:55], a[160:163], v[192:195], v[52:55]
    buffer_load_dwordx4 v14, s[8:11], s29 offen lds
    v_mfma_f32_16x16x32_bf16 v[52:55], a[148:151], v[44:47], v[52:55]
    v_mfma_f32_16x16x32_bf16 v[56:59], a[152:155], v[44:47], v[56:59]
    ds_read_b128 v[36:39], v9 offset:34048
    v_mfma_f32_16x16x32_bf16 v[56:59], a[164:167], v[192:195], v[56:59]
    v_mfma_f32_16x16x32_bf16 v[56:59], a[176:179], v[196:199], v[56:59]
    v_mfma_f32_16x16x32_bf16 v[68:71], a[176:179], v[200:203], v[68:71]
    v_mfma_f32_16x16x32_bf16 v[68:71], a[164:167], v[196:199], v[68:71]
    v_mfma_f32_16x16x32_bf16 v[68:71], a[152:155], v[192:195], v[68:71]
    v_mfma_f32_16x16x32_bf16 v[80:83], a[152:155], v[196:199], v[80:83]
    s_add_u32 m0, s28, 69632
    s_add_u32 s29, s42, 155648
    v_mfma_f32_16x16x32_bf16 v[80:83], a[164:167], v[200:203], v[80:83]
    buffer_load_dwordx4 v14, s[8:11], s29 offen lds
    v_mfma_f32_16x16x32_bf16 v[80:83], a[176:179], v[16:19], v[80:83]
    s_waitcnt vmcnt(9)
    s_barrier
    s_waitcnt lgkmcnt(1)
    v_mfma_f32_16x16x32_bf16 v[84:87], a[144:147], v[20:23], v[84:87]
    ds_read_b64_tr_b16 a[180:181], v10 offset:18432
    ds_read_b64_tr_b16 a[182:183], v10 offset:19200
    v_mfma_f32_16x16x32_bf16 v[84:87], a[156:159], v[24:27], v[84:87]
    ds_read_b64_tr_b16 a[192:193], v10 offset:24576
    ds_read_b64_tr_b16 a[194:195], v10 offset:25344
    v_mfma_f32_16x16x32_bf16 v[84:87], a[168:171], v[28:31], v[84:87]
    ds_read_b64_tr_b16 a[204:205], v10 offset:30720
    ds_read_b64_tr_b16 a[206:207], v10 offset:31488
    v_mfma_f32_16x16x32_bf16 v[96:99], a[168:171], v[32:35], v[96:99]
    ds_read_b64_tr_b16 a[184:185], v10 offset:18440
    ds_read_b64_tr_b16 a[186:187], v10 offset:19208
    v_mfma_f32_16x16x32_bf16 v[96:99], a[156:159], v[28:31], v[96:99]
    ds_read_b64_tr_b16 a[196:197], v10 offset:24584
    ds_read_b64_tr_b16 a[198:199], v10 offset:25352
    v_mfma_f32_16x16x32_bf16 v[96:99], a[144:147], v[24:27], v[96:99]
    ds_read_b64_tr_b16 a[208:209], v10 offset:30728
    s_waitcnt lgkmcnt(11)
    v_mfma_f32_16x16x32_bf16 v[108:111], a[144:147], v[28:31], v[108:111]
    ds_read_b64_tr_b16 a[210:211], v10 offset:31496
    ds_read_b64_tr_b16 a[188:189], v12 offset:18432
    v_mfma_f32_16x16x32_bf16 v[108:111], a[156:159], v[32:35], v[108:111]
    s_add_u32 m0, s28, 0
    s_add_u32 s29, s42, 122880
    v_mfma_f32_16x16x32_bf16 v[108:111], a[168:171], v[36:39], v[108:111]
    ds_read_b64_tr_b16 a[190:191], v12 offset:19200
    ds_read_b64_tr_b16 a[200:201], v12 offset:24576
    v_mfma_f32_16x16x32_bf16 v[112:115], a[172:175], v[36:39], v[112:115]
    ds_read_b64_tr_b16 a[202:203], v12 offset:25344
    ds_read_b64_tr_b16 a[212:213], v12 offset:30720
    v_mfma_f32_16x16x32_bf16 v[112:115], a[160:163], v[32:35], v[112:115]
    buffer_load_dwordx4 v14, s[8:11], s29 offen lds
    v_mfma_f32_16x16x32_bf16 v[112:115], a[148:151], v[28:31], v[112:115]
    ds_read_b64_tr_b16 a[214:215], v12 offset:31488
    v_mfma_f32_16x16x32_bf16 v[100:103], a[148:151], v[24:27], v[100:103]
    ds_read_b128 v[40:43], v7 offset:10752
    v_mfma_f32_16x16x32_bf16 v[100:103], a[160:163], v[28:31], v[100:103]
    ds_read_b128 v[44:47], v8 offset:13824
    v_mfma_f32_16x16x32_bf16 v[100:103], a[172:175], v[32:35], v[100:103]
    ds_read_b128 v[192:195], v9 offset:16896
    v_mfma_f32_16x16x32_bf16 v[88:91], a[172:175], v[28:31], v[88:91]
    ds_read_b128 v[196:199], v8 offset:10752
    v_mfma_f32_16x16x32_bf16 v[88:91], a[160:163], v[24:27], v[88:91]
    v_mfma_f32_16x16x32_bf16 v[88:91], a[148:151], v[20:23], v[88:91]
    v_mfma_f32_16x16x32_bf16 v[92:95], a[152:155], v[20:23], v[92:95]
    ds_read_b128 v[200:203], v9 offset:13824
    s_add_u32 m0, s28, 4096
    v_mfma_f32_16x16x32_bf16 v[92:95], a[164:167], v[24:27], v[92:95]
    s_add_u32 s29, s47, 126976
    v_mfma_f32_16x16x32_bf16 v[92:95], a[176:179], v[28:31], v[92:95]
    v_mfma_f32_16x16x32_bf16 v[104:107], a[176:179], v[32:35], v[104:107]
    v_mfma_f32_16x16x32_bf16 v[104:107], a[164:167], v[28:31], v[104:107]
    buffer_load_dwordx4 v14, s[8:11], s29 offen lds
    v_mfma_f32_16x16x32_bf16 v[104:107], a[152:155], v[24:27], v[104:107]
    v_mfma_f32_16x16x32_bf16 v[116:119], a[152:155], v[28:31], v[116:119]
    v_mfma_f32_16x16x32_bf16 v[116:119], a[164:167], v[32:35], v[116:119]
    v_mfma_f32_16x16x32_bf16 v[116:119], a[176:179], v[36:39], v[116:119]
    s_waitcnt lgkmcnt(5)
    s_waitcnt lgkmcnt(1)
    v_mfma_f32_16x16x32_bf16 v[48:51], a[180:183], v[40:43], v[48:51]
    v_mfma_f32_16x16x32_bf16 v[48:51], a[192:195], v[44:47], v[48:51]
    v_mfma_f32_16x16x32_bf16 v[48:51], a[204:207], v[192:195], v[48:51]
    s_add_u32 m0, s28, 8192
    s_add_u32 s29, s42, 143360
    v_mfma_f32_16x16x32_bf16 v[60:63], a[204:207], v[196:199], v[60:63]
    v_mfma_f32_16x16x32_bf16 v[60:63], a[192:195], v[192:195], v[60:63]
    buffer_load_dwordx4 v14, s[8:11], s29 offen lds
    v_mfma_f32_16x16x32_bf16 v[60:63], a[180:183], v[44:47], v[60:63]
    s_waitcnt lgkmcnt(0)
    v_mfma_f32_16x16x32_bf16 v[72:75], a[180:183], v[192:195], v[72:75]
    v_mfma_f32_16x16x32_bf16 v[72:75], a[192:195], v[196:199], v[72:75]
    v_mfma_f32_16x16x32_bf16 v[72:75], a[204:207], v[200:203], v[72:75]
    v_mfma_f32_16x16x32_bf16 v[76:79], a[208:211], v[200:203], v[76:79]
    v_mfma_f32_16x16x32_bf16 v[76:79], a[196:199], v[196:199], v[76:79]
    v_mfma_f32_16x16x32_bf16 v[76:79], a[184:187], v[192:195], v[76:79]
    v_mfma_f32_16x16x32_bf16 v[64:67], a[184:187], v[44:47], v[64:67]
    ds_read_b128 v[16:19], v7 offset:31232
    v_mfma_f32_16x16x32_bf16 v[64:67], a[196:199], v[192:195], v[64:67]
    ds_read_b128 v[20:23], v8 offset:34304
    s_add_u32 m0, s28, 12288
    v_mfma_f32_16x16x32_bf16 v[64:67], a[208:211], v[196:199], v[64:67]
    ds_read_b128 v[24:27], v9 offset:37376
    s_add_u32 s29, s42, 159744
    v_mfma_f32_16x16x32_bf16 v[52:55], a[208:211], v[192:195], v[52:55]
    ds_read_b128 v[28:31], v8 offset:31232
    v_mfma_f32_16x16x32_bf16 v[52:55], a[196:199], v[44:47], v[52:55]
    buffer_load_dwordx4 v14, s[8:11], s29 offen lds
    v_mfma_f32_16x16x32_bf16 v[52:55], a[184:187], v[40:43], v[52:55]
    v_mfma_f32_16x16x32_bf16 v[56:59], a[188:191], v[40:43], v[56:59]
    ds_read_b128 v[32:35], v9 offset:34304
    v_mfma_f32_16x16x32_bf16 v[56:59], a[200:203], v[44:47], v[56:59]
    v_mfma_f32_16x16x32_bf16 v[56:59], a[212:215], v[192:195], v[56:59]
    v_mfma_f32_16x16x32_bf16 v[68:71], a[212:215], v[196:199], v[68:71]
    v_mfma_f32_16x16x32_bf16 v[68:71], a[200:203], v[192:195], v[68:71]
    v_mfma_f32_16x16x32_bf16 v[68:71], a[188:191], v[44:47], v[68:71]
    v_mfma_f32_16x16x32_bf16 v[80:83], a[188:191], v[192:195], v[80:83]
    v_mfma_f32_16x16x32_bf16 v[80:83], a[200:203], v[196:199], v[80:83]
    v_mfma_f32_16x16x32_bf16 v[80:83], a[212:215], v[200:203], v[80:83]
    s_waitcnt vmcnt(8)
    s_barrier
    s_waitcnt lgkmcnt(1)
    v_mfma_f32_16x16x32_bf16 v[84:87], a[180:183], v[16:19], v[84:87]
    s_add_u32 m0, s28, 16384
    s_add_u32 s29, s43, 163840
    v_mfma_f32_16x16x32_bf16 v[84:87], a[192:195], v[20:23], v[84:87]
    buffer_load_dwordx4 v14, s[8:11], s29 offen lds
    v_mfma_f32_16x16x32_bf16 v[84:87], a[204:207], v[24:27], v[84:87]
    ds_read_b64_tr_b16 a[216:217], v11 offset:0
    ds_read_b64_tr_b16 a[218:219], v11 offset:768
    v_mfma_f32_16x16x32_bf16 v[96:99], a[204:207], v[28:31], v[96:99]
    ds_read_b64_tr_b16 a[228:229], v11 offset:6144
    ds_read_b64_tr_b16 a[230:231], v11 offset:6912
    v_mfma_f32_16x16x32_bf16 v[96:99], a[192:195], v[24:27], v[96:99]
    ds_read_b64_tr_b16 a[240:241], v11 offset:12288
    ds_read_b64_tr_b16 a[242:243], v11 offset:13056
    v_mfma_f32_16x16x32_bf16 v[96:99], a[180:183], v[20:23], v[96:99]
    ds_read_b64_tr_b16 a[220:221], v11 offset:8
    s_waitcnt lgkmcnt(7)
    v_mfma_f32_16x16x32_bf16 v[108:111], a[180:183], v[24:27], v[108:111]
    ds_read_b64_tr_b16 a[222:223], v11 offset:776
    ds_read_b64_tr_b16 a[232:233], v11 offset:6152
    v_mfma_f32_16x16x32_bf16 v[108:111], a[192:195], v[28:31], v[108:111]
    ds_read_b64_tr_b16 a[234:235], v11 offset:6920
    ds_read_b64_tr_b16 a[244:245], v11 offset:12296
    v_mfma_f32_16x16x32_bf16 v[108:111], a[204:207], v[32:35], v[108:111]
    ds_read_b64_tr_b16 a[246:247], v11 offset:13064
    ds_read_b64_tr_b16 a[224:225], v13 offset:0
    v_mfma_f32_16x16x32_bf16 v[112:115], a[208:211], v[32:35], v[112:115]
    ds_read_b64_tr_b16 a[226:227], v13 offset:768
    ds_read_b64_tr_b16 a[236:237], v13 offset:6144
    v_mfma_f32_16x16x32_bf16 v[112:115], a[196:199], v[28:31], v[112:115]
    s_add_u32 m0, s27, 61440
    s_mov_b32 s26, s25
    v_mfma_f32_16x16x32_bf16 v[112:115], a[184:187], v[24:27], v[112:115]
    ds_read_b64_tr_b16 a[238:239], v13 offset:6912
    ds_read_b64_tr_b16 a[248:249], v13 offset:12288
    v_mfma_f32_16x16x32_bf16 v[100:103], a[184:187], v[20:23], v[100:103]
    ds_read_b128 v[36:39], v7 offset:20480
    ds_read_b64_tr_b16 a[250:251], v13 offset:13056
    v_mfma_f32_16x16x32_bf16 v[100:103], a[196:199], v[24:27], v[100:103]
    ds_read_b128 v[40:43], v8 offset:23552
    v_mfma_f32_16x16x32_bf16 v[100:103], a[208:211], v[28:31], v[100:103]
    ds_read_b128 v[44:47], v9 offset:26624
    v_mfma_f32_16x16x32_bf16 v[88:91], a[208:211], v[24:27], v[88:91]
    ds_read_b128 v[192:195], v8 offset:20480
    v_mfma_f32_16x16x32_bf16 v[88:91], a[196:199], v[20:23], v[88:91]
    buffer_load_dwordx4 v2, s[4:7], s26 offen nt lds
    v_mfma_f32_16x16x32_bf16 v[88:91], a[184:187], v[16:19], v[88:91]
    v_mfma_f32_16x16x32_bf16 v[92:95], a[188:191], v[16:19], v[92:95]
    ds_read_b128 v[196:199], v9 offset:23552
    v_mfma_f32_16x16x32_bf16 v[92:95], a[200:203], v[20:23], v[92:95]
    v_mfma_f32_16x16x32_bf16 v[92:95], a[212:215], v[24:27], v[92:95]
    v_mfma_f32_16x16x32_bf16 v[104:107], a[212:215], v[28:31], v[104:107]
    v_mfma_f32_16x16x32_bf16 v[104:107], a[200:203], v[24:27], v[104:107]
    v_mfma_f32_16x16x32_bf16 v[104:107], a[188:191], v[20:23], v[104:107]
    v_mfma_f32_16x16x32_bf16 v[116:119], a[188:191], v[24:27], v[116:119]
    s_add_u32 m0, s27, 62464
    s_add_u32 s25, s25, s44
    v_mfma_f32_16x16x32_bf16 v[116:119], a[200:203], v[28:31], v[116:119]
    buffer_load_dwordx4 v3, s[4:7], s26 offen nt lds
    v_mfma_f32_16x16x32_bf16 v[116:119], a[212:215], v[32:35], v[116:119]
    s_waitcnt lgkmcnt(4)
    s_waitcnt lgkmcnt(1)
    v_mfma_f32_16x16x32_bf16 v[48:51], a[216:219], v[36:39], v[48:51]
    v_mfma_f32_16x16x32_bf16 v[48:51], a[228:231], v[40:43], v[48:51]
    v_mfma_f32_16x16x32_bf16 v[48:51], a[240:243], v[44:47], v[48:51]
    v_mfma_f32_16x16x32_bf16 v[60:63], a[240:243], v[192:195], v[60:63]
    v_mfma_f32_16x16x32_bf16 v[60:63], a[228:231], v[44:47], v[60:63]
    v_mfma_f32_16x16x32_bf16 v[60:63], a[216:219], v[40:43], v[60:63]
    s_waitcnt lgkmcnt(0)
    v_mfma_f32_16x16x32_bf16 v[72:75], a[216:219], v[44:47], v[72:75]
    v_mfma_f32_16x16x32_bf16 v[72:75], a[228:231], v[192:195], v[72:75]
    v_mfma_f32_16x16x32_bf16 v[72:75], a[240:243], v[196:199], v[72:75]
    v_mfma_f32_16x16x32_bf16 v[76:79], a[244:247], v[196:199], v[76:79]
    v_mfma_f32_16x16x32_bf16 v[76:79], a[232:235], v[192:195], v[76:79]
    s_add_u32 m0, s27, 63488
    v_mfma_f32_16x16x32_bf16 v[76:79], a[220:223], v[44:47], v[76:79]
    v_mfma_f32_16x16x32_bf16 v[64:67], a[220:223], v[40:43], v[64:67]
    ds_read_b128 v[200:203], v7 offset:40960
    v_mfma_f32_16x16x32_bf16 v[64:67], a[232:235], v[44:47], v[64:67]
    ds_read_b128 v[16:19], v8 offset:44032
    v_mfma_f32_16x16x32_bf16 v[64:67], a[244:247], v[192:195], v[64:67]
    ds_read_b128 v[20:23], v9 offset:47104
    v_mfma_f32_16x16x32_bf16 v[52:55], a[244:247], v[44:47], v[52:55]
    ds_read_b128 v[24:27], v8 offset:40960
    v_mfma_f32_16x16x32_bf16 v[52:55], a[232:235], v[40:43], v[52:55]
    buffer_load_dwordx4 v4, s[4:7], s26 offen nt lds
    v_mfma_f32_16x16x32_bf16 v[52:55], a[220:223], v[36:39], v[52:55]
    v_mfma_f32_16x16x32_bf16 v[56:59], a[224:227], v[36:39], v[56:59]
    ds_read_b128 v[28:31], v9 offset:44032
    v_mfma_f32_16x16x32_bf16 v[56:59], a[236:239], v[40:43], v[56:59]
    v_mfma_f32_16x16x32_bf16 v[56:59], a[248:251], v[44:47], v[56:59]
    v_mfma_f32_16x16x32_bf16 v[68:71], a[248:251], v[192:195], v[68:71]
    v_mfma_f32_16x16x32_bf16 v[68:71], a[236:239], v[44:47], v[68:71]
    v_mfma_f32_16x16x32_bf16 v[68:71], a[224:227], v[40:43], v[68:71]
    v_mfma_f32_16x16x32_bf16 v[80:83], a[224:227], v[44:47], v[80:83]
    s_add_u32 m0, s27, 64512
    v_mfma_f32_16x16x32_bf16 v[80:83], a[236:239], v[192:195], v[80:83]
    buffer_load_dwordx4 v5, s[4:7], s26 offen nt lds
    v_mfma_f32_16x16x32_bf16 v[80:83], a[248:251], v[196:199], v[80:83]
    s_waitcnt vmcnt(9)
    s_barrier
    s_waitcnt lgkmcnt(1)
    v_mfma_f32_16x16x32_bf16 v[84:87], a[216:219], v[200:203], v[84:87]
    ds_read_b64_tr_b16 a[252:253], v11 offset:18432
    ds_read_b64_tr_b16 a[254:255], v11 offset:19200
    v_mfma_f32_16x16x32_bf16 v[84:87], a[228:231], v[16:19], v[84:87]
    ds_read_b64_tr_b16 v[128:129], v11 offset:24576
    ds_read_b64_tr_b16 v[130:131], v11 offset:25344
    v_mfma_f32_16x16x32_bf16 v[84:87], a[240:243], v[20:23], v[84:87]
    ds_read_b64_tr_b16 v[140:141], v11 offset:30720
    ds_read_b64_tr_b16 v[142:143], v11 offset:31488
    v_mfma_f32_16x16x32_bf16 v[96:99], a[240:243], v[24:27], v[96:99]
    ds_read_b64_tr_b16 v[120:121], v11 offset:18440
    ds_read_b64_tr_b16 v[122:123], v11 offset:19208
    v_mfma_f32_16x16x32_bf16 v[96:99], a[228:231], v[20:23], v[96:99]
    ds_read_b64_tr_b16 v[132:133], v11 offset:24584
    ds_read_b64_tr_b16 v[134:135], v11 offset:25352
    v_mfma_f32_16x16x32_bf16 v[96:99], a[216:219], v[16:19], v[96:99]
    ds_read_b64_tr_b16 v[144:145], v11 offset:30728
    s_waitcnt lgkmcnt(11)
    v_mfma_f32_16x16x32_bf16 v[108:111], a[216:219], v[20:23], v[108:111]
    ds_read_b64_tr_b16 v[146:147], v11 offset:31496
    ds_read_b64_tr_b16 v[124:125], v13 offset:18432
    v_mfma_f32_16x16x32_bf16 v[108:111], a[228:231], v[24:27], v[108:111]
    s_add_u32 m0, s27, 65536
    ds_read_b64_tr_b16 v[126:127], v13 offset:19200
    v_mfma_f32_16x16x32_bf16 v[108:111], a[240:243], v[28:31], v[108:111]
    ds_read_b64_tr_b16 v[136:137], v13 offset:24576
    ds_read_b64_tr_b16 v[138:139], v13 offset:25344
    v_mfma_f32_16x16x32_bf16 v[112:115], a[244:247], v[28:31], v[112:115]
    ds_read_b64_tr_b16 v[148:149], v13 offset:30720
    ds_read_b64_tr_b16 v[150:151], v13 offset:31488
    v_mfma_f32_16x16x32_bf16 v[112:115], a[232:235], v[24:27], v[112:115]
    buffer_load_dwordx4 v6, s[4:7], s26 offen nt lds
    v_mfma_f32_16x16x32_bf16 v[112:115], a[220:223], v[20:23], v[112:115]
    v_mfma_f32_16x16x32_bf16 v[100:103], a[220:223], v[16:19], v[100:103]
    ds_read_b128 v[32:35], v7 offset:20736
    v_mfma_f32_16x16x32_bf16 v[100:103], a[232:235], v[20:23], v[100:103]
    ds_read_b128 v[36:39], v8 offset:23808
    v_mfma_f32_16x16x32_bf16 v[100:103], a[244:247], v[24:27], v[100:103]
    ds_read_b128 v[40:43], v9 offset:26880
    v_mfma_f32_16x16x32_bf16 v[88:91], a[244:247], v[20:23], v[88:91]
    ds_read_b128 v[44:47], v8 offset:20736
    v_mfma_f32_16x16x32_bf16 v[88:91], a[232:235], v[16:19], v[88:91]
    v_mfma_f32_16x16x32_bf16 v[88:91], a[220:223], v[200:203], v[88:91]
    v_mfma_f32_16x16x32_bf16 v[92:95], a[224:227], v[200:203], v[92:95]
    ds_read_b128 v[192:195], v9 offset:23808
    v_mfma_f32_16x16x32_bf16 v[92:95], a[236:239], v[16:19], v[92:95]
    v_mfma_f32_16x16x32_bf16 v[92:95], a[248:251], v[20:23], v[92:95]
    v_mfma_f32_16x16x32_bf16 v[104:107], a[248:251], v[24:27], v[104:107]
    v_mfma_f32_16x16x32_bf16 v[104:107], a[236:239], v[20:23], v[104:107]
    v_mfma_f32_16x16x32_bf16 v[104:107], a[224:227], v[16:19], v[104:107]
    v_mfma_f32_16x16x32_bf16 v[116:119], a[224:227], v[20:23], v[116:119]
    v_mfma_f32_16x16x32_bf16 v[116:119], a[236:239], v[24:27], v[116:119]
    v_mfma_f32_16x16x32_bf16 v[116:119], a[248:251], v[28:31], v[116:119]
    s_waitcnt lgkmcnt(5)
    s_waitcnt lgkmcnt(1)
    v_mfma_f32_16x16x32_bf16 v[48:51], a[252:255], v[32:35], v[48:51]
    v_mfma_f32_16x16x32_bf16 v[48:51], v[128:131], v[36:39], v[48:51]
    v_mfma_f32_16x16x32_bf16 v[48:51], v[140:143], v[40:43], v[48:51]
    v_mfma_f32_16x16x32_bf16 v[60:63], v[140:143], v[44:47], v[60:63]
    v_mfma_f32_16x16x32_bf16 v[60:63], v[128:131], v[40:43], v[60:63]
    v_mfma_f32_16x16x32_bf16 v[60:63], a[252:255], v[36:39], v[60:63]
    s_waitcnt lgkmcnt(0)
    v_mfma_f32_16x16x32_bf16 v[72:75], a[252:255], v[40:43], v[72:75]
    v_mfma_f32_16x16x32_bf16 v[72:75], v[128:131], v[44:47], v[72:75]
    v_mfma_f32_16x16x32_bf16 v[72:75], v[140:143], v[192:195], v[72:75]
    v_mfma_f32_16x16x32_bf16 v[76:79], v[144:147], v[192:195], v[76:79]
    v_mfma_f32_16x16x32_bf16 v[76:79], v[132:135], v[44:47], v[76:79]
    v_mfma_f32_16x16x32_bf16 v[76:79], v[120:123], v[40:43], v[76:79]
    v_mfma_f32_16x16x32_bf16 v[64:67], v[120:123], v[36:39], v[64:67]
    ds_read_b128 v[196:199], v7 offset:41216
    v_mfma_f32_16x16x32_bf16 v[64:67], v[132:135], v[40:43], v[64:67]
    ds_read_b128 v[200:203], v8 offset:44288
    v_mfma_f32_16x16x32_bf16 v[64:67], v[144:147], v[44:47], v[64:67]
    ds_read_b128 v[16:19], v9 offset:47360
    v_mfma_f32_16x16x32_bf16 v[52:55], v[144:147], v[40:43], v[52:55]
    ds_read_b128 v[20:23], v8 offset:41216
    v_mfma_f32_16x16x32_bf16 v[52:55], v[132:135], v[36:39], v[52:55]
    v_mfma_f32_16x16x32_bf16 v[52:55], v[120:123], v[32:35], v[52:55]
    v_mfma_f32_16x16x32_bf16 v[56:59], v[124:127], v[32:35], v[56:59]
    ds_read_b128 v[24:27], v9 offset:44288
    v_mfma_f32_16x16x32_bf16 v[56:59], v[136:139], v[36:39], v[56:59]
    v_mfma_f32_16x16x32_bf16 v[56:59], v[148:151], v[40:43], v[56:59]
    v_mfma_f32_16x16x32_bf16 v[68:71], v[148:151], v[44:47], v[68:71]
    v_mfma_f32_16x16x32_bf16 v[68:71], v[136:139], v[40:43], v[68:71]
    v_mfma_f32_16x16x32_bf16 v[68:71], v[124:127], v[36:39], v[68:71]
    v_mfma_f32_16x16x32_bf16 v[80:83], v[124:127], v[40:43], v[80:83]
    v_mfma_f32_16x16x32_bf16 v[80:83], v[136:139], v[44:47], v[80:83]
    v_mfma_f32_16x16x32_bf16 v[80:83], v[148:151], v[192:195], v[80:83]
    s_waitcnt vmcnt(5)
    s_barrier
    s_waitcnt lgkmcnt(1)
    v_mfma_f32_16x16x32_bf16 v[84:87], a[252:255], v[196:199], v[84:87]
    ds_read_b64_tr_b16 v[152:153], v10 offset:0
    ds_read_b64_tr_b16 v[154:155], v10 offset:768
    v_mfma_f32_16x16x32_bf16 v[84:87], v[128:131], v[200:203], v[84:87]
    ds_read_b64_tr_b16 v[164:165], v10 offset:6144
    ds_read_b64_tr_b16 v[166:167], v10 offset:6912
    v_mfma_f32_16x16x32_bf16 v[84:87], v[140:143], v[16:19], v[84:87]
    ds_read_b64_tr_b16 v[176:177], v10 offset:12288
    ds_read_b64_tr_b16 v[178:179], v10 offset:13056
    v_mfma_f32_16x16x32_bf16 v[96:99], v[140:143], v[20:23], v[96:99]
    ds_read_b64_tr_b16 v[156:157], v10 offset:8
    ds_read_b64_tr_b16 v[158:159], v10 offset:776
    v_mfma_f32_16x16x32_bf16 v[96:99], v[128:131], v[16:19], v[96:99]
    ds_read_b64_tr_b16 v[168:169], v10 offset:6152
    ds_read_b64_tr_b16 v[170:171], v10 offset:6920
    v_mfma_f32_16x16x32_bf16 v[96:99], a[252:255], v[200:203], v[96:99]
    ds_read_b64_tr_b16 v[180:181], v10 offset:12296
    s_waitcnt lgkmcnt(11)
    v_mfma_f32_16x16x32_bf16 v[108:111], a[252:255], v[16:19], v[108:111]
    ds_read_b64_tr_b16 v[182:183], v10 offset:13064
    ds_read_b64_tr_b16 v[160:161], v12 offset:0
    v_mfma_f32_16x16x32_bf16 v[108:111], v[128:131], v[20:23], v[108:111]
    ds_read_b64_tr_b16 v[162:163], v12 offset:768
    ds_read_b64_tr_b16 v[172:173], v12 offset:6144
    v_mfma_f32_16x16x32_bf16 v[108:111], v[140:143], v[24:27], v[108:111]
    ds_read_b64_tr_b16 v[174:175], v12 offset:6912
    ds_read_b64_tr_b16 v[184:185], v12 offset:12288
    v_mfma_f32_16x16x32_bf16 v[112:115], v[144:147], v[24:27], v[112:115]
    ds_read_b64_tr_b16 v[186:187], v12 offset:13056
    v_mfma_f32_16x16x32_bf16 v[112:115], v[132:135], v[20:23], v[112:115]
    v_mfma_f32_16x16x32_bf16 v[112:115], v[120:123], v[16:19], v[112:115]
    v_mfma_f32_16x16x32_bf16 v[100:103], v[120:123], v[200:203], v[100:103]
    ds_read_b128 v[28:31], v7 offset:20992
    v_mfma_f32_16x16x32_bf16 v[100:103], v[132:135], v[16:19], v[100:103]
    ds_read_b128 v[32:35], v8 offset:24064
    v_mfma_f32_16x16x32_bf16 v[100:103], v[144:147], v[20:23], v[100:103]
    ds_read_b128 v[36:39], v9 offset:27136
    v_mfma_f32_16x16x32_bf16 v[88:91], v[144:147], v[16:19], v[88:91]
    v_mfma_f32_16x16x32_bf16 v[88:91], v[132:135], v[200:203], v[88:91]
    v_mfma_f32_16x16x32_bf16 v[88:91], v[120:123], v[196:199], v[88:91]
    v_mfma_f32_16x16x32_bf16 v[92:95], v[124:127], v[196:199], v[92:95]
    v_mfma_f32_16x16x32_bf16 v[92:95], v[136:139], v[200:203], v[92:95]
    v_mfma_f32_16x16x32_bf16 v[92:95], v[148:151], v[16:19], v[92:95]
    v_mfma_f32_16x16x32_bf16 v[104:107], v[148:151], v[20:23], v[104:107]
    ds_read_b128 v[40:43], v8 offset:20992
    v_mfma_f32_16x16x32_bf16 v[104:107], v[136:139], v[16:19], v[104:107]
    v_mfma_f32_16x16x32_bf16 v[104:107], v[124:127], v[200:203], v[104:107]
    v_mfma_f32_16x16x32_bf16 v[116:119], v[124:127], v[16:19], v[116:119]
    v_mfma_f32_16x16x32_bf16 v[116:119], v[136:139], v[20:23], v[116:119]
    v_mfma_f32_16x16x32_bf16 v[116:119], v[148:151], v[24:27], v[116:119]
    s_waitcnt lgkmcnt(4)
    s_waitcnt lgkmcnt(1)
    v_mfma_f32_16x16x32_bf16 v[48:51], v[152:155], v[28:31], v[48:51]
    v_mfma_f32_16x16x32_bf16 v[48:51], v[164:167], v[32:35], v[48:51]
    v_mfma_f32_16x16x32_bf16 v[48:51], v[176:179], v[36:39], v[48:51]
    v_mfma_f32_16x16x32_bf16 v[52:55], v[180:183], v[36:39], v[52:55]
    ds_read_b128 v[44:47], v9 offset:24064
    v_mfma_f32_16x16x32_bf16 v[52:55], v[168:171], v[32:35], v[52:55]
    v_mfma_f32_16x16x32_bf16 v[52:55], v[156:159], v[28:31], v[52:55]
    v_mfma_f32_16x16x32_bf16 v[56:59], v[160:163], v[28:31], v[56:59]
    v_mfma_f32_16x16x32_bf16 v[56:59], v[172:175], v[32:35], v[56:59]
    v_mfma_f32_16x16x32_bf16 v[56:59], v[184:187], v[36:39], v[56:59]
    s_barrier
    s_waitcnt lgkmcnt(1)
    v_mfma_f32_16x16x32_bf16 v[68:71], v[184:187], v[40:43], v[68:71]
    s_add_u32 m0, s27, 81920
    s_mov_b32 s26, s25
    v_mfma_f32_16x16x32_bf16 v[68:71], v[172:175], v[36:39], v[68:71]
    buffer_load_dwordx4 v2, s[4:7], s26 offen nt lds
    v_mfma_f32_16x16x32_bf16 v[68:71], v[160:163], v[32:35], v[68:71]
    s_add_u32 m0, s27, 82944
    s_add_u32 s25, s25, s44
    v_mfma_f32_16x16x32_bf16 v[64:67], v[156:159], v[32:35], v[64:67]
    ds_read_b128 v[192:195], v7 offset:41472
    v_mfma_f32_16x16x32_bf16 v[64:67], v[168:171], v[36:39], v[64:67]
    ds_read_b128 v[196:199], v8 offset:44544
    v_mfma_f32_16x16x32_bf16 v[64:67], v[180:183], v[40:43], v[64:67]
    ds_read_b128 v[200:203], v9 offset:47616
    v_mfma_f32_16x16x32_bf16 v[60:63], v[176:179], v[40:43], v[60:63]
    v_cvt_pk_bf16_f32 v48, v48, v49
    v_cvt_pk_bf16_f32 v49, v50, v51
    v_mfma_f32_16x16x32_bf16 v[60:63], v[164:167], v[36:39], v[60:63]
    buffer_load_dwordx4 v3, s[4:7], s26 offen nt lds
    v_mfma_f32_16x16x32_bf16 v[60:63], v[152:155], v[32:35], v[60:63]
    s_add_u32 m0, s27, 83968
    s_waitcnt lgkmcnt(3)
    v_mfma_f32_16x16x32_bf16 v[72:75], v[152:155], v[36:39], v[72:75]
    v_cvt_pk_bf16_f32 v50, v52, v53
    v_cvt_pk_bf16_f32 v51, v54, v55
    v_mfma_f32_16x16x32_bf16 v[72:75], v[164:167], v[40:43], v[72:75]
    buffer_load_dwordx4 v4, s[4:7], s26 offen nt lds
    v_mfma_f32_16x16x32_bf16 v[72:75], v[176:179], v[44:47], v[72:75]
    s_add_u32 m0, s27, 84992
    ds_write_b128 v206, v[48:51] offset:0
    v_mfma_f32_16x16x32_bf16 v[76:79], v[180:183], v[44:47], v[76:79]
    ds_read_b128 v[16:19], v8 offset:41472
    v_cvt_pk_bf16_f32 v56, v56, v57
    v_mfma_f32_16x16x32_bf16 v[76:79], v[168:171], v[40:43], v[76:79]
    buffer_load_dwordx4 v5, s[4:7], s26 offen nt lds
    v_mfma_f32_16x16x32_bf16 v[76:79], v[156:159], v[36:39], v[76:79]
    s_add_u32 m0, s27, 86016
    v_cvt_pk_bf16_f32 v57, v58, v59
    v_mfma_f32_16x16x32_bf16 v[80:83], v[160:163], v[36:39], v[80:83]
    ds_write_b64 v207, v[56:57] offset:0
    v_cvt_pk_bf16_f32 v60, v60, v61
    v_mfma_f32_16x16x32_bf16 v[80:83], v[172:175], v[40:43], v[80:83]
    buffer_load_dwordx4 v6, s[4:7], s26 offen nt lds
    v_mfma_f32_16x16x32_bf16 v[80:83], v[184:187], v[44:47], v[80:83]
    v_cvt_pk_bf16_f32 v61, v62, v63
    s_waitcnt lgkmcnt(3)
    v_mfma_f32_16x16x32_bf16 v[84:87], v[152:155], v[192:195], v[84:87]
    v_cvt_pk_bf16_f32 v62, v64, v65
    v_cvt_pk_bf16_f32 v63, v66, v67
    v_mfma_f32_16x16x32_bf16 v[84:87], v[164:167], v[196:199], v[84:87]
    s_add_u32 m0, s27, 102400
    s_mov_b32 s26, s25
    v_mfma_f32_16x16x32_bf16 v[84:87], v[176:179], v[200:203], v[84:87]
    ds_write_b128 v206, v[60:63] offset:3200
    v_cvt_pk_bf16_f32 v68, v68, v69
    v_mfma_f32_16x16x32_bf16 v[88:91], v[180:183], v[200:203], v[88:91]
    ds_read_b128 v[20:23], v9 offset:44544
    v_cvt_pk_bf16_f32 v69, v70, v71
    v_mfma_f32_16x16x32_bf16 v[88:91], v[168:171], v[196:199], v[88:91]
    buffer_load_dwordx4 v2, s[4:7], s26 offen nt lds
    v_mfma_f32_16x16x32_bf16 v[88:91], v[156:159], v[192:195], v[88:91]
    ds_write_b64 v207, v[68:69] offset:3200
    v_mfma_f32_16x16x32_bf16 v[92:95], v[160:163], v[192:195], v[92:95]
    v_cvt_pk_bf16_f32 v72, v72, v73
    v_cvt_pk_bf16_f32 v73, v74, v75
    v_mfma_f32_16x16x32_bf16 v[92:95], v[172:175], v[196:199], v[92:95]
    v_cvt_pk_bf16_f32 v74, v76, v77
    v_cvt_pk_bf16_f32 v75, v78, v79
    v_mfma_f32_16x16x32_bf16 v[92:95], v[184:187], v[200:203], v[92:95]
    ds_write_b128 v206, v[72:75] offset:6400
    s_waitcnt lgkmcnt(5)
    v_mfma_f32_16x16x32_bf16 v[104:107], v[184:187], v[16:19], v[104:107]
    v_cvt_pk_bf16_f32 v80, v80, v81
    v_cvt_pk_bf16_f32 v81, v82, v83
    v_mfma_f32_16x16x32_bf16 v[104:107], v[172:175], v[200:203], v[104:107]
    ds_write_b64 v207, v[80:81] offset:6400
    v_mfma_f32_16x16x32_bf16 v[104:107], v[160:163], v[196:199], v[104:107]
    v_mfma_f32_16x16x32_bf16 v[100:103], v[156:159], v[196:199], v[100:103]
    v_add_u32 v7, 40960, v7
    v_add_u32 v8, 40960, v8
    v_add_u32 v9, 40960, v9
    ds_read_b128 v[24:27], v7 offset:0
    v_mfma_f32_16x16x32_bf16 v[100:103], v[168:171], v[200:203], v[100:103]
    ds_read_b128 v[28:31], v8 offset:3072
    v_mfma_f32_16x16x32_bf16 v[100:103], v[180:183], v[16:19], v[100:103]
    ds_read_b128 v[32:35], v9 offset:6144
    v_mfma_f32_16x16x32_bf16 v[96:99], v[176:179], v[16:19], v[96:99]
    ds_read_b128 v[36:39], v8 offset:0
    v_mfma_f32_16x16x32_bf16 v[96:99], v[164:167], v[200:203], v[96:99]
    v_mfma_f32_16x16x32_bf16 v[96:99], v[152:155], v[196:199], v[96:99]
    s_waitcnt lgkmcnt(7)
    v_mfma_f32_16x16x32_bf16 v[108:111], v[152:155], v[200:203], v[108:111]
    ds_read_b128 v[40:43], v9 offset:3072
    v_mfma_f32_16x16x32_bf16 v[108:111], v[164:167], v[16:19], v[108:111]
    v_mfma_f32_16x16x32_bf16 v[108:111], v[176:179], v[20:23], v[108:111]
    v_mfma_f32_16x16x32_bf16 v[112:115], v[180:183], v[20:23], v[112:115]
    v_mfma_f32_16x16x32_bf16 v[112:115], v[168:171], v[16:19], v[112:115]
    v_mfma_f32_16x16x32_bf16 v[112:115], v[156:159], v[200:203], v[112:115]
    v_mfma_f32_16x16x32_bf16 v[116:119], v[160:163], v[200:203], v[116:119]
    v_mfma_f32_16x16x32_bf16 v[116:119], v[172:175], v[16:19], v[116:119]
    v_mfma_f32_16x16x32_bf16 v[116:119], v[184:187], v[20:23], v[116:119]
    s_waitcnt lgkmcnt(1)
    v_mfma_f32_16x16x32_bf16 v[48:51], a[0:3], v[24:27], 0
    v_mfma_f32_16x16x32_bf16 v[48:51], a[12:15], v[28:31], v[48:51]
    v_mfma_f32_16x16x32_bf16 v[48:51], a[24:27], v[32:35], v[48:51]
    s_barrier
    v_mfma_f32_16x16x32_bf16 v[60:63], a[24:27], v[36:39], 0
    ds_read_b128 v[212:215], v208 offset:0
    ds_read_b128 v[216:219], v209 offset:0
    v_mfma_f32_16x16x32_bf16 v[60:63], a[12:15], v[32:35], v[60:63]
    s_add_u32 m0, s27, 103424
    s_add_u32 s25, s25, s44
    v_mfma_f32_16x16x32_bf16 v[60:63], a[0:3], v[28:31], v[60:63]
    ds_read_b128 v[220:223], v210 offset:0
    s_waitcnt lgkmcnt(3)
    v_mfma_f32_16x16x32_bf16 v[72:75], a[0:3], v[32:35], 0
    ds_read_b128 v[224:227], v232 offset:0
    ds_read_b128 v[228:231], v233 offset:0
    v_mfma_f32_16x16x32_bf16 v[72:75], a[12:15], v[36:39], v[72:75]
    buffer_load_dwordx4 v3, s[4:7], s26 offen nt lds
    v_mfma_f32_16x16x32_bf16 v[72:75], a[24:27], v[40:43], v[72:75]
    v_cvt_pk_bf16_f32 v84, v84, v85
    v_cvt_pk_bf16_f32 v85, v86, v87
    v_mfma_f32_16x16x32_bf16 v[76:79], a[28:31], v[40:43], 0
    s_waitcnt lgkmcnt(4)
    v_cvt_pk_bf16_f32 v86, v88, v89
    v_mfma_f32_16x16x32_bf16 v[76:79], a[16:19], v[36:39], v[76:79]
    buffer_store_dwordx4 v[212:215], v15, s[12:15], s33 offen offset:0 nt
    v_mfma_f32_16x16x32_bf16 v[76:79], a[4:7], v[32:35], v[76:79]
    s_waitcnt lgkmcnt(3)
    v_cvt_pk_bf16_f32 v87, v90, v91
    v_mfma_f32_16x16x32_bf16 v[64:67], a[4:7], v[28:31], 0
    ds_read_b128 v[44:47], v9 offset:6400
    ds_write_b128 v206, v[84:87] offset:20480
    v_mfma_f32_16x16x32_bf16 v[64:67], a[16:19], v[32:35], v[64:67]
    ds_read_b128 v[192:195], v8 offset:256
    v_cvt_pk_bf16_f32 v92, v92, v93
    v_mfma_f32_16x16x32_bf16 v[64:67], a[28:31], v[36:39], v[64:67]
    ds_read_b128 v[196:199], v9 offset:3328
    v_cvt_pk_bf16_f32 v93, v94, v95
    v_mfma_f32_16x16x32_bf16 v[52:55], a[28:31], v[32:35], 0
    ds_read_b128 v[200:203], v8 offset:3328
    ds_write_b64 v207, v[92:93] offset:20480
    v_mfma_f32_16x16x32_bf16 v[52:55], a[16:19], v[28:31], v[52:55]
    v_cvt_pk_bf16_f32 v96, v96, v97
    v_cvt_pk_bf16_f32 v97, v98, v99
    v_mfma_f32_16x16x32_bf16 v[52:55], a[4:7], v[24:27], v[52:55]
    v_cvt_pk_bf16_f32 v98, v100, v101
    v_cvt_pk_bf16_f32 v99, v102, v103
    v_mfma_f32_16x16x32_bf16 v[56:59], a[8:11], v[24:27], 0
    ds_read_b128 v[16:19], v7 offset:256
    ds_write_b128 v206, v[96:99] offset:23680
    v_mfma_f32_16x16x32_bf16 v[56:59], a[20:23], v[28:31], v[56:59]
    v_cvt_pk_bf16_f32 v104, v104, v105
    v_cvt_pk_bf16_f32 v105, v106, v107
    v_mfma_f32_16x16x32_bf16 v[56:59], a[32:35], v[32:35], v[56:59]
    ds_write_b64 v207, v[104:105] offset:23680
    v_cvt_pk_bf16_f32 v108, v108, v109
    v_mfma_f32_16x16x32_bf16 v[68:71], a[32:35], v[36:39], 0
    v_cvt_pk_bf16_f32 v109, v110, v111
    v_cvt_pk_bf16_f32 v110, v112, v113
    v_mfma_f32_16x16x32_bf16 v[68:71], a[20:23], v[32:35], v[68:71]
    buffer_store_dwordx4 v[216:219], v15, s[12:15], s33 offen offset:1024 nt
    v_mfma_f32_16x16x32_bf16 v[68:71], a[8:11], v[28:31], v[68:71]
    s_waitcnt lgkmcnt(11)
    v_cvt_pk_bf16_f32 v111, v114, v115
    v_mfma_f32_16x16x32_bf16 v[80:83], a[8:11], v[32:35], 0
    ds_write_b128 v206, v[108:111] offset:26880
    v_cvt_pk_bf16_f32 v116, v116, v117
    v_mfma_f32_16x16x32_bf16 v[80:83], a[20:23], v[36:39], v[80:83]
    v_cvt_pk_bf16_f32 v117, v118, v119
    ds_write_b64 v207, v[116:117] offset:26880
    v_mfma_f32_16x16x32_bf16 v[80:83], a[32:35], v[40:43], v[80:83]
    s_waitcnt lgkmcnt(6)
    v_mfma_f32_16x16x32_bf16 v[80:83], a[44:47], v[44:47], v[80:83]
    v_mfma_f32_16x16x32_bf16 v[80:83], a[56:59], v[192:195], v[80:83]
    v_mfma_f32_16x16x32_bf16 v[80:83], a[68:71], v[196:199], v[80:83]
    v_mfma_f32_16x16x32_bf16 v[68:71], a[68:71], v[192:195], v[68:71]
    v_mfma_f32_16x16x32_bf16 v[68:71], a[56:59], v[44:47], v[68:71]
    v_mfma_f32_16x16x32_bf16 v[68:71], a[44:47], v[200:203], v[68:71]
    s_waitcnt lgkmcnt(4)
    v_mfma_f32_16x16x32_bf16 v[56:59], a[44:47], v[16:19], v[56:59]
    v_mfma_f32_16x16x32_bf16 v[56:59], a[56:59], v[200:203], v[56:59]
    buffer_store_dwordx4 v[220:223], v15, s[12:15], s33 offen offset:2048 nt
    v_mfma_f32_16x16x32_bf16 v[56:59], a[68:71], v[44:47], v[56:59]
    v_mfma_f32_16x16x32_bf16 v[52:55], a[64:67], v[44:47], v[52:55]
    v_mfma_f32_16x16x32_bf16 v[52:55], a[52:55], v[200:203], v[52:55]
    v_mfma_f32_16x16x32_bf16 v[52:55], a[40:43], v[16:19], v[52:55]
    v_mfma_f32_16x16x32_bf16 v[64:67], a[40:43], v[200:203], v[64:67]
    ds_read_b128 v[20:23], v7 offset:512
    v_mfma_f32_16x16x32_bf16 v[64:67], a[52:55], v[44:47], v[64:67]
    ds_read_b128 v[24:27], v8 offset:3584
    v_mfma_f32_16x16x32_bf16 v[64:67], a[64:67], v[192:195], v[64:67]
    ds_read_b128 v[28:31], v9 offset:6656
    v_mfma_f32_16x16x32_bf16 v[76:79], a[64:67], v[196:199], v[76:79]
    ds_read_b128 v[32:35], v8 offset:512
    v_mfma_f32_16x16x32_bf16 v[76:79], a[52:55], v[192:195], v[76:79]
    v_mfma_f32_16x16x32_bf16 v[76:79], a[40:43], v[44:47], v[76:79]
    v_mfma_f32_16x16x32_bf16 v[72:75], a[36:39], v[44:47], v[72:75]
    ds_read_b128 v[36:39], v9 offset:3584
    v_mfma_f32_16x16x32_bf16 v[72:75], a[48:51], v[192:195], v[72:75]
    buffer_store_dwordx4 v[224:227], v15, s[12:15], s33 offen offset:3072 nt
    v_mfma_f32_16x16x32_bf16 v[72:75], a[60:63], v[196:199], v[72:75]
    v_mfma_f32_16x16x32_bf16 v[60:63], a[60:63], v[192:195], v[60:63]
    v_mfma_f32_16x16x32_bf16 v[60:63], a[48:51], v[44:47], v[60:63]
    v_mfma_f32_16x16x32_bf16 v[60:63], a[36:39], v[200:203], v[60:63]
    v_mfma_f32_16x16x32_bf16 v[48:51], a[36:39], v[16:19], v[48:51]
    v_mfma_f32_16x16x32_bf16 v[48:51], a[48:51], v[200:203], v[48:51]
    v_mfma_f32_16x16x32_bf16 v[48:51], a[60:63], v[44:47], v[48:51]
    s_waitcnt lgkmcnt(1)
    v_mfma_f32_16x16x32_bf16 v[48:51], a[72:75], v[20:23], v[48:51]
    v_mfma_f32_16x16x32_bf16 v[48:51], a[84:87], v[24:27], v[48:51]
    v_mfma_f32_16x16x32_bf16 v[48:51], a[96:99], v[28:31], v[48:51]
    v_mfma_f32_16x16x32_bf16 v[60:63], a[96:99], v[32:35], v[60:63]
    v_mfma_f32_16x16x32_bf16 v[60:63], a[84:87], v[28:31], v[60:63]
    buffer_store_dwordx4 v[228:231], v188, s[12:15], s33 offen nt
    s_add_u32 s33, s33, s44
    v_mfma_f32_16x16x32_bf16 v[60:63], a[72:75], v[24:27], v[60:63]
    s_add_u32 m0, s27, 104448
    s_waitcnt lgkmcnt(0)
    v_mfma_f32_16x16x32_bf16 v[72:75], a[72:75], v[28:31], v[72:75]
    v_mfma_f32_16x16x32_bf16 v[72:75], a[84:87], v[32:35], v[72:75]
    v_mfma_f32_16x16x32_bf16 v[72:75], a[96:99], v[36:39], v[72:75]
    v_mfma_f32_16x16x32_bf16 v[76:79], a[100:103], v[36:39], v[76:79]
    v_mfma_f32_16x16x32_bf16 v[76:79], a[88:91], v[32:35], v[76:79]
    v_mfma_f32_16x16x32_bf16 v[76:79], a[76:79], v[28:31], v[76:79]
    buffer_load_dwordx4 v4, s[4:7], s26 offen nt lds
    s_waitcnt vmcnt(13)
    s_barrier
    v_mfma_f32_16x16x32_bf16 v[64:67], a[76:79], v[24:27], v[64:67]
    ds_read_b128 v[40:43], v9 offset:16384
    s_add_u32 m0, s27, 105472
    v_mfma_f32_16x16x32_bf16 v[64:67], a[88:91], v[28:31], v[64:67]
    ds_read_b128 v[44:47], v8 offset:10240
    ds_read_b128 v[212:215], v208 offset:20480
    v_mfma_f32_16x16x32_bf16 v[64:67], a[100:103], v[32:35], v[64:67]
    ds_read_b128 v[192:195], v9 offset:13312
    ds_read_b128 v[216:219], v209 offset:20480
    v_mfma_f32_16x16x32_bf16 v[52:55], a[100:103], v[28:31], v[52:55]
    ds_read_b128 v[196:199], v8 offset:13312
    ds_read_b128 v[220:223], v210 offset:20480
    v_mfma_f32_16x16x32_bf16 v[52:55], a[88:91], v[24:27], v[52:55]
    buffer_load_dwordx4 v5, s[4:7], s26 offen nt lds
    v_mfma_f32_16x16x32_bf16 v[52:55], a[76:79], v[20:23], v[52:55]
    ds_read_b128 v[224:227], v232 offset:20480
    ds_read_b128 v[228:231], v233 offset:20480
    v_mfma_f32_16x16x32_bf16 v[56:59], a[80:83], v[20:23], v[56:59]
    ds_read_b128 v[200:203], v7 offset:10240
    s_waitcnt lgkmcnt(7)
    v_mfma_f32_16x16x32_bf16 v[56:59], a[92:95], v[24:27], v[56:59]
    buffer_store_dwordx4 v[212:215], v15, s[12:15], s33 offen offset:0 nt
    v_mfma_f32_16x16x32_bf16 v[56:59], a[104:107], v[28:31], v[56:59]
    s_waitcnt lgkmcnt(5)
    v_mfma_f32_16x16x32_bf16 v[68:71], a[104:107], v[32:35], v[68:71]
    v_mfma_f32_16x16x32_bf16 v[68:71], a[92:95], v[28:31], v[68:71]
    v_mfma_f32_16x16x32_bf16 v[68:71], a[80:83], v[24:27], v[68:71]
    v_mfma_f32_16x16x32_bf16 v[80:83], a[80:83], v[28:31], v[80:83]
    v_mfma_f32_16x16x32_bf16 v[80:83], a[92:95], v[32:35], v[80:83]
    v_mfma_f32_16x16x32_bf16 v[80:83], a[104:107], v[36:39], v[80:83]
    s_waitcnt lgkmcnt(4)
    v_mfma_f32_16x16x32_bf16 v[80:83], a[116:119], v[40:43], v[80:83]
    v_mfma_f32_16x16x32_bf16 v[80:83], a[128:131], v[44:47], v[80:83]
    v_mfma_f32_16x16x32_bf16 v[80:83], a[140:143], v[192:195], v[80:83]
    v_mfma_f32_16x16x32_bf16 v[68:71], a[140:143], v[44:47], v[68:71]
    v_mfma_f32_16x16x32_bf16 v[68:71], a[128:131], v[40:43], v[68:71]
    buffer_store_dwordx4 v[216:219], v15, s[12:15], s33 offen offset:1024 nt
    v_mfma_f32_16x16x32_bf16 v[68:71], a[116:119], v[196:199], v[68:71]
    s_waitcnt lgkmcnt(3)
    s_waitcnt lgkmcnt(0)
    v_mfma_f32_16x16x32_bf16 v[56:59], a[116:119], v[200:203], v[56:59]
    v_mfma_f32_16x16x32_bf16 v[56:59], a[128:131], v[196:199], v[56:59]
    v_mfma_f32_16x16x32_bf16 v[56:59], a[140:143], v[40:43], v[56:59]
    v_mfma_f32_16x16x32_bf16 v[52:55], a[136:139], v[40:43], v[52:55]
    v_mfma_f32_16x16x32_bf16 v[52:55], a[124:127], v[196:199], v[52:55]
    v_mfma_f32_16x16x32_bf16 v[52:55], a[112:115], v[200:203], v[52:55]
    v_mfma_f32_16x16x32_bf16 v[64:67], a[112:115], v[196:199], v[64:67]
    ds_read_b128 v[16:19], v7 offset:10496
    v_mfma_f32_16x16x32_bf16 v[64:67], a[124:127], v[40:43], v[64:67]
    ds_read_b128 v[20:23], v8 offset:13568
    v_mfma_f32_16x16x32_bf16 v[64:67], a[136:139], v[44:47], v[64:67]
    ds_read_b128 v[24:27], v9 offset:16640
    v_mfma_f32_16x16x32_bf16 v[76:79], a[136:139], v[192:195], v[76:79]
    ds_read_b128 v[28:31], v8 offset:10496
    v_mfma_f32_16x16x32_bf16 v[76:79], a[124:127], v[44:47], v[76:79]
    buffer_store_dwordx4 v[220:223], v15, s[12:15], s33 offen offset:2048 nt
    v_mfma_f32_16x16x32_bf16 v[76:79], a[112:115], v[40:43], v[76:79]
    v_mfma_f32_16x16x32_bf16 v[72:75], a[108:111], v[40:43], v[72:75]
    ds_read_b128 v[32:35], v9 offset:13568
    v_mfma_f32_16x16x32_bf16 v[72:75], a[120:123], v[44:47], v[72:75]
    v_mfma_f32_16x16x32_bf16 v[72:75], a[132:135], v[192:195], v[72:75]
    v_mfma_f32_16x16x32_bf16 v[60:63], a[132:135], v[44:47], v[60:63]
    v_mfma_f32_16x16x32_bf16 v[60:63], a[120:123], v[40:43], v[60:63]
    v_mfma_f32_16x16x32_bf16 v[60:63], a[108:111], v[196:199], v[60:63]
    v_mfma_f32_16x16x32_bf16 v[48:51], a[108:111], v[200:203], v[48:51]
    v_mfma_f32_16x16x32_bf16 v[48:51], a[120:123], v[196:199], v[48:51]
    v_mfma_f32_16x16x32_bf16 v[48:51], a[132:135], v[40:43], v[48:51]
    s_waitcnt lgkmcnt(1)
    v_mfma_f32_16x16x32_bf16 v[48:51], a[144:147], v[16:19], v[48:51]
    v_mfma_f32_16x16x32_bf16 v[48:51], a[156:159], v[20:23], v[48:51]
    buffer_store_dwordx4 v[224:227], v15, s[12:15], s33 offen offset:3072 nt
    v_mfma_f32_16x16x32_bf16 v[48:51], a[168:171], v[24:27], v[48:51]
    v_mfma_f32_16x16x32_bf16 v[60:63], a[168:171], v[28:31], v[60:63]
    v_mfma_f32_16x16x32_bf16 v[60:63], a[156:159], v[24:27], v[60:63]
    v_mfma_f32_16x16x32_bf16 v[60:63], a[144:147], v[20:23], v[60:63]
    s_waitcnt lgkmcnt(0)
    v_mfma_f32_16x16x32_bf16 v[72:75], a[144:147], v[24:27], v[72:75]
    v_mfma_f32_16x16x32_bf16 v[72:75], a[156:159], v[28:31], v[72:75]
    v_mfma_f32_16x16x32_bf16 v[72:75], a[168:171], v[32:35], v[72:75]
    v_mfma_f32_16x16x32_bf16 v[76:79], a[172:175], v[32:35], v[76:79]
    v_mfma_f32_16x16x32_bf16 v[76:79], a[160:163], v[28:31], v[76:79]
    v_mfma_f32_16x16x32_bf16 v[76:79], a[148:151], v[24:27], v[76:79]
    v_mfma_f32_16x16x32_bf16 v[64:67], a[148:151], v[20:23], v[64:67]
    ds_read_b128 v[36:39], v9 offset:16896
    v_mfma_f32_16x16x32_bf16 v[64:67], a[160:163], v[24:27], v[64:67]
    ds_read_b128 v[40:43], v8 offset:10752
    v_mfma_f32_16x16x32_bf16 v[64:67], a[172:175], v[28:31], v[64:67]
    ds_read_b128 v[44:47], v9 offset:13824
    v_mfma_f32_16x16x32_bf16 v[52:55], a[172:175], v[24:27], v[52:55]
    ds_read_b128 v[192:195], v8 offset:13824
    v_mfma_f32_16x16x32_bf16 v[52:55], a[160:163], v[20:23], v[52:55]
    buffer_store_dwordx4 v[228:231], v188, s[12:15], s33 offen nt
    s_add_u32 s33, s33, s44
    v_mfma_f32_16x16x32_bf16 v[52:55], a[148:151], v[16:19], v[52:55]
    s_add_u32 m0, s27, 106496
    v_mfma_f32_16x16x32_bf16 v[56:59], a[152:155], v[16:19], v[56:59]
    ds_read_b128 v[196:199], v7 offset:10752
    v_mfma_f32_16x16x32_bf16 v[56:59], a[164:167], v[20:23], v[56:59]
    v_mfma_f32_16x16x32_bf16 v[56:59], a[176:179], v[24:27], v[56:59]
    v_mfma_f32_16x16x32_bf16 v[68:71], a[176:179], v[28:31], v[68:71]
    v_mfma_f32_16x16x32_bf16 v[68:71], a[164:167], v[24:27], v[68:71]
    v_mfma_f32_16x16x32_bf16 v[68:71], a[152:155], v[20:23], v[68:71]
    v_mfma_f32_16x16x32_bf16 v[80:83], a[152:155], v[24:27], v[80:83]
    v_mfma_f32_16x16x32_bf16 v[80:83], a[164:167], v[28:31], v[80:83]
    v_mfma_f32_16x16x32_bf16 v[80:83], a[176:179], v[32:35], v[80:83]
    s_waitcnt lgkmcnt(1)
    v_mfma_f32_16x16x32_bf16 v[80:83], a[188:191], v[36:39], v[80:83]
    v_mfma_f32_16x16x32_bf16 v[80:83], a[200:203], v[40:43], v[80:83]
    buffer_load_dwordx4 v6, s[4:7], s26 offen nt lds
    v_mfma_f32_16x16x32_bf16 v[80:83], a[212:215], v[44:47], v[80:83]
    v_mfma_f32_16x16x32_bf16 v[68:71], a[212:215], v[40:43], v[68:71]
    v_mfma_f32_16x16x32_bf16 v[68:71], a[200:203], v[36:39], v[68:71]
    v_mfma_f32_16x16x32_bf16 v[68:71], a[188:191], v[192:195], v[68:71]
    s_waitcnt lgkmcnt(0)
    v_mfma_f32_16x16x32_bf16 v[56:59], a[188:191], v[196:199], v[56:59]
    v_mfma_f32_16x16x32_bf16 v[56:59], a[200:203], v[192:195], v[56:59]
    v_mfma_f32_16x16x32_bf16 v[56:59], a[212:215], v[36:39], v[56:59]
    v_mfma_f32_16x16x32_bf16 v[52:55], a[208:211], v[36:39], v[52:55]
    v_mfma_f32_16x16x32_bf16 v[52:55], a[196:199], v[192:195], v[52:55]
    v_mfma_f32_16x16x32_bf16 v[52:55], a[184:187], v[196:199], v[52:55]
    v_mfma_f32_16x16x32_bf16 v[64:67], a[184:187], v[192:195], v[64:67]
    ds_read_b128 v[200:203], v7 offset:20480
    v_mfma_f32_16x16x32_bf16 v[64:67], a[196:199], v[36:39], v[64:67]
    ds_read_b128 v[16:19], v8 offset:23552
    v_mfma_f32_16x16x32_bf16 v[64:67], a[208:211], v[40:43], v[64:67]
    ds_read_b128 v[20:23], v9 offset:26624
    v_mfma_f32_16x16x32_bf16 v[76:79], a[208:211], v[44:47], v[76:79]
    ds_read_b128 v[24:27], v8 offset:20480
    v_mfma_f32_16x16x32_bf16 v[76:79], a[196:199], v[40:43], v[76:79]
    v_mfma_f32_16x16x32_bf16 v[76:79], a[184:187], v[36:39], v[76:79]
    v_mfma_f32_16x16x32_bf16 v[72:75], a[180:183], v[36:39], v[72:75]
    ds_read_b128 v[28:31], v9 offset:23552
    v_mfma_f32_16x16x32_bf16 v[72:75], a[192:195], v[40:43], v[72:75]
    v_mfma_f32_16x16x32_bf16 v[72:75], a[204:207], v[44:47], v[72:75]
    v_mfma_f32_16x16x32_bf16 v[60:63], a[204:207], v[40:43], v[60:63]
    v_mfma_f32_16x16x32_bf16 v[60:63], a[192:195], v[36:39], v[60:63]
    v_mfma_f32_16x16x32_bf16 v[60:63], a[180:183], v[192:195], v[60:63]
    v_mfma_f32_16x16x32_bf16 v[48:51], a[180:183], v[196:199], v[48:51]
    v_mfma_f32_16x16x32_bf16 v[48:51], a[192:195], v[192:195], v[48:51]
    s_add_u32 m0, s27, 122880
    s_cmp_lt_i32 s25, 0
    s_cselect_b32 s26, 0x40000000, s25
    v_mfma_f32_16x16x32_bf16 v[48:51], a[204:207], v[36:39], v[48:51]
    s_waitcnt lgkmcnt(1)
    v_mfma_f32_16x16x32_bf16 v[48:51], a[216:219], v[200:203], v[48:51]
    v_mfma_f32_16x16x32_bf16 v[48:51], a[228:231], v[16:19], v[48:51]
    buffer_load_dwordx4 v2, s[4:7], s26 offen nt lds
    v_mfma_f32_16x16x32_bf16 v[48:51], a[240:243], v[20:23], v[48:51]
    v_mfma_f32_16x16x32_bf16 v[60:63], a[240:243], v[24:27], v[60:63]
    v_mfma_f32_16x16x32_bf16 v[60:63], a[228:231], v[20:23], v[60:63]
    v_mfma_f32_16x16x32_bf16 v[60:63], a[216:219], v[16:19], v[60:63]
    s_waitcnt lgkmcnt(0)
    v_mfma_f32_16x16x32_bf16 v[72:75], a[216:219], v[20:23], v[72:75]
    v_mfma_f32_16x16x32_bf16 v[72:75], a[228:231], v[24:27], v[72:75]
    v_mfma_f32_16x16x32_bf16 v[72:75], a[240:243], v[28:31], v[72:75]
    v_mfma_f32_16x16x32_bf16 v[76:79], a[244:247], v[28:31], v[76:79]
    v_mfma_f32_16x16x32_bf16 v[76:79], a[232:235], v[24:27], v[76:79]
    v_mfma_f32_16x16x32_bf16 v[76:79], a[220:223], v[20:23], v[76:79]
    v_mfma_f32_16x16x32_bf16 v[64:67], a[220:223], v[16:19], v[64:67]
    ds_read_b128 v[32:35], v9 offset:26880
    v_mfma_f32_16x16x32_bf16 v[64:67], a[232:235], v[20:23], v[64:67]
    ds_read_b128 v[36:39], v8 offset:20736
    v_mfma_f32_16x16x32_bf16 v[64:67], a[244:247], v[24:27], v[64:67]
    ds_read_b128 v[40:43], v9 offset:23808
    v_mfma_f32_16x16x32_bf16 v[52:55], a[244:247], v[20:23], v[52:55]
    ds_read_b128 v[44:47], v8 offset:23808
    v_mfma_f32_16x16x32_bf16 v[52:55], a[232:235], v[16:19], v[52:55]
    v_mfma_f32_16x16x32_bf16 v[52:55], a[220:223], v[200:203], v[52:55]
    v_mfma_f32_16x16x32_bf16 v[56:59], a[224:227], v[200:203], v[56:59]
    ds_read_b128 v[192:195], v7 offset:20736
    v_mfma_f32_16x16x32_bf16 v[56:59], a[236:239], v[16:19], v[56:59]
    v_mfma_f32_16x16x32_bf16 v[56:59], a[248:251], v[20:23], v[56:59]
    v_mfma_f32_16x16x32_bf16 v[68:71], a[248:251], v[24:27], v[68:71]
    v_mfma_f32_16x16x32_bf16 v[68:71], a[236:239], v[20:23], v[68:71]
    v_mfma_f32_16x16x32_bf16 v[68:71], a[224:227], v[16:19], v[68:71]
    v_mfma_f32_16x16x32_bf16 v[80:83], a[224:227], v[20:23], v[80:83]
    v_mfma_f32_16x16x32_bf16 v[80:83], a[236:239], v[24:27], v[80:83]
    v_mfma_f32_16x16x32_bf16 v[80:83], a[248:251], v[28:31], v[80:83]
    s_waitcnt lgkmcnt(1)
    v_mfma_f32_16x16x32_bf16 v[80:83], v[124:127], v[32:35], v[80:83]
    v_mfma_f32_16x16x32_bf16 v[80:83], v[136:139], v[36:39], v[80:83]
    v_mfma_f32_16x16x32_bf16 v[80:83], v[148:151], v[40:43], v[80:83]
    v_mfma_f32_16x16x32_bf16 v[68:71], v[148:151], v[36:39], v[68:71]
    v_mfma_f32_16x16x32_bf16 v[68:71], v[136:139], v[32:35], v[68:71]
    v_mfma_f32_16x16x32_bf16 v[68:71], v[124:127], v[44:47], v[68:71]
    s_waitcnt lgkmcnt(0)
    v_mfma_f32_16x16x32_bf16 v[56:59], v[124:127], v[192:195], v[56:59]
    v_mfma_f32_16x16x32_bf16 v[56:59], v[136:139], v[44:47], v[56:59]
    v_mfma_f32_16x16x32_bf16 v[56:59], v[148:151], v[32:35], v[56:59]
    v_mfma_f32_16x16x32_bf16 v[52:55], v[144:147], v[32:35], v[52:55]
    v_mfma_f32_16x16x32_bf16 v[52:55], v[132:135], v[44:47], v[52:55]
    v_mfma_f32_16x16x32_bf16 v[52:55], v[120:123], v[192:195], v[52:55]
    v_mfma_f32_16x16x32_bf16 v[64:67], v[120:123], v[44:47], v[64:67]
    ds_read_b128 v[196:199], v7 offset:20992
    v_mfma_f32_16x16x32_bf16 v[64:67], v[132:135], v[32:35], v[64:67]
    ds_read_b128 v[200:203], v8 offset:24064
    v_mfma_f32_16x16x32_bf16 v[64:67], v[144:147], v[36:39], v[64:67]
    ds_read_b128 v[16:19], v9 offset:27136
    v_mfma_f32_16x16x32_bf16 v[76:79], v[144:147], v[40:43], v[76:79]
    v_mfma_f32_16x16x32_bf16 v[76:79], v[132:135], v[36:39], v[76:79]
    v_mfma_f32_16x16x32_bf16 v[76:79], v[120:123], v[32:35], v[76:79]
    v_mfma_f32_16x16x32_bf16 v[72:75], a[252:255], v[32:35], v[72:75]
    v_mfma_f32_16x16x32_bf16 v[72:75], v[128:131], v[36:39], v[72:75]
    s_add_u32 m0, s27, 123904
    s_add_u32 s25, s25, s44
    v_mfma_f32_16x16x32_bf16 v[72:75], v[140:143], v[40:43], v[72:75]
    v_mfma_f32_16x16x32_bf16 v[60:63], v[140:143], v[36:39], v[60:63]
    ds_read_b128 v[20:23], v8 offset:20992
    v_mfma_f32_16x16x32_bf16 v[60:63], v[128:131], v[32:35], v[60:63]
    buffer_load_dwordx4 v3, s[4:7], s26 offen nt lds
    v_mfma_f32_16x16x32_bf16 v[60:63], a[252:255], v[44:47], v[60:63]
    v_mfma_f32_16x16x32_bf16 v[48:51], a[252:255], v[192:195], v[48:51]
    v_mfma_f32_16x16x32_bf16 v[48:51], v[128:131], v[44:47], v[48:51]
    v_mfma_f32_16x16x32_bf16 v[48:51], v[140:143], v[32:35], v[48:51]
    s_waitcnt lgkmcnt(1)
    v_mfma_f32_16x16x32_bf16 v[48:51], v[152:155], v[196:199], v[48:51]
    v_mfma_f32_16x16x32_bf16 v[48:51], v[164:167], v[200:203], v[48:51]
    v_mfma_f32_16x16x32_bf16 v[48:51], v[176:179], v[16:19], v[48:51]
    v_mfma_f32_16x16x32_bf16 v[52:55], v[180:183], v[16:19], v[52:55]
    ds_read_b128 v[24:27], v9 offset:24064
    v_mfma_f32_16x16x32_bf16 v[52:55], v[168:171], v[200:203], v[52:55]
    v_mfma_f32_16x16x32_bf16 v[52:55], v[156:159], v[196:199], v[52:55]
    v_mfma_f32_16x16x32_bf16 v[56:59], v[160:163], v[196:199], v[56:59]
    v_mfma_f32_16x16x32_bf16 v[56:59], v[172:175], v[200:203], v[56:59]
    v_mfma_f32_16x16x32_bf16 v[56:59], v[184:187], v[16:19], v[56:59]
    s_waitcnt lgkmcnt(1)
    v_mfma_f32_16x16x32_bf16 v[68:71], v[184:187], v[20:23], v[68:71]
    v_mfma_f32_16x16x32_bf16 v[68:71], v[172:175], v[16:19], v[68:71]
    v_mfma_f32_16x16x32_bf16 v[68:71], v[160:163], v[200:203], v[68:71]
    v_mfma_f32_16x16x32_bf16 v[64:67], v[156:159], v[200:203], v[64:67]
    ds_read_b128 v[28:31], v7 offset:20480
    v_mfma_f32_16x16x32_bf16 v[64:67], v[168:171], v[16:19], v[64:67]
    ds_read_b128 v[32:35], v8 offset:23552
    v_mfma_f32_16x16x32_bf16 v[64:67], v[180:183], v[20:23], v[64:67]
    ds_read_b128 v[36:39], v9 offset:26624
    v_mfma_f32_16x16x32_bf16 v[60:63], v[176:179], v[20:23], v[60:63]
    ds_read_b128 v[40:43], v8 offset:20480
    v_cvt_pk_bf16_f32 v48, v48, v49
    v_mfma_f32_16x16x32_bf16 v[60:63], v[164:167], v[16:19], v[60:63]
    v_cvt_pk_bf16_f32 v49, v50, v51
    v_cvt_pk_bf16_f32 v50, v52, v53
    v_mfma_f32_16x16x32_bf16 v[60:63], v[152:155], v[200:203], v[60:63]
    v_cvt_pk_bf16_f32 v51, v54, v55
    s_waitcnt lgkmcnt(4)
    v_mfma_f32_16x16x32_bf16 v[72:75], v[152:155], v[16:19], v[72:75]
    ds_read_b128 v[44:47], v9 offset:23552
    ds_write_b128 v206, v[48:51] offset:0
    v_mfma_f32_16x16x32_bf16 v[72:75], v[164:167], v[20:23], v[72:75]
    v_cvt_pk_bf16_f32 v56, v56, v57
    v_cvt_pk_bf16_f32 v57, v58, v59
    v_mfma_f32_16x16x32_bf16 v[72:75], v[176:179], v[24:27], v[72:75]
    ds_write_b64 v207, v[56:57] offset:0
    v_mfma_f32_16x16x32_bf16 v[76:79], v[180:183], v[24:27], v[76:79]
    v_mfma_f32_16x16x32_bf16 v[76:79], v[168:171], v[20:23], v[76:79]
    v_mfma_f32_16x16x32_bf16 v[76:79], v[156:159], v[16:19], v[76:79]
    v_mfma_f32_16x16x32_bf16 v[80:83], v[160:163], v[16:19], v[80:83]
    v_cvt_pk_bf16_f32 v60, v60, v61
    v_cvt_pk_bf16_f32 v61, v62, v63
    v_mfma_f32_16x16x32_bf16 v[80:83], v[172:175], v[20:23], v[80:83]
    v_cvt_pk_bf16_f32 v62, v64, v65
    v_cvt_pk_bf16_f32 v63, v66, v67
    v_mfma_f32_16x16x32_bf16 v[80:83], v[184:187], v[24:27], v[80:83]
    ds_write_b128 v206, v[60:63] offset:3200
    s_waitcnt lgkmcnt(4)
    v_mfma_f32_16x16x32_bf16 v[84:87], a[0:3], v[28:31], 0
    v_cvt_pk_bf16_f32 v68, v68, v69
    v_cvt_pk_bf16_f32 v69, v70, v71
    v_mfma_f32_16x16x32_bf16 v[84:87], a[12:15], v[32:35], v[84:87]
    ds_write_b64 v207, v[68:69] offset:3200
    v_mfma_f32_16x16x32_bf16 v[84:87], a[24:27], v[36:39], v[84:87]
    v_mfma_f32_16x16x32_bf16 v[96:99], a[24:27], v[40:43], 0
    v_mfma_f32_16x16x32_bf16 v[96:99], a[12:15], v[36:39], v[96:99]
    v_mfma_f32_16x16x32_bf16 v[96:99], a[0:3], v[32:35], v[96:99]
    s_waitcnt lgkmcnt(4)
    v_mfma_f32_16x16x32_bf16 v[108:111], a[0:3], v[36:39], 0
    v_cvt_pk_bf16_f32 v72, v72, v73
    v_cvt_pk_bf16_f32 v73, v74, v75
    v_mfma_f32_16x16x32_bf16 v[108:111], a[12:15], v[40:43], v[108:111]
    v_cvt_pk_bf16_f32 v74, v76, v77
    v_cvt_pk_bf16_f32 v75, v78, v79
    v_mfma_f32_16x16x32_bf16 v[108:111], a[24:27], v[44:47], v[108:111]
    ds_write_b128 v206, v[72:75] offset:6400
    v_cvt_pk_bf16_f32 v80, v80, v81
    v_mfma_f32_16x16x32_bf16 v[112:115], a[28:31], v[44:47], 0
    v_cvt_pk_bf16_f32 v81, v82, v83
    ds_write_b64 v207, v[80:81] offset:6400
    v_mfma_f32_16x16x32_bf16 v[112:115], a[16:19], v[40:43], v[112:115]
    v_mfma_f32_16x16x32_bf16 v[112:115], a[4:7], v[36:39], v[112:115]
    v_mfma_f32_16x16x32_bf16 v[100:103], a[4:7], v[32:35], 0
    ds_read_b128 v[192:195], v9 offset:26880
    v_mfma_f32_16x16x32_bf16 v[100:103], a[16:19], v[36:39], v[100:103]
    ds_read_b128 v[196:199], v8 offset:20736
    v_mfma_f32_16x16x32_bf16 v[100:103], a[28:31], v[40:43], v[100:103]
    ds_read_b128 v[200:203], v9 offset:23808
    s_add_u32 m0, s27, 124928
    v_mfma_f32_16x16x32_bf16 v[88:91], a[28:31], v[36:39], 0
    ds_read_b128 v[16:19], v8 offset:23808
    v_mfma_f32_16x16x32_bf16 v[88:91], a[16:19], v[32:35], v[88:91]
    buffer_load_dwordx4 v4, s[4:7], s26 offen nt lds
    v_mfma_f32_16x16x32_bf16 v[88:91], a[4:7], v[28:31], v[88:91]
    v_mfma_f32_16x16x32_bf16 v[92:95], a[8:11], v[28:31], 0
    ds_read_b128 v[20:23], v7 offset:20736
    v_mfma_f32_16x16x32_bf16 v[92:95], a[20:23], v[32:35], v[92:95]
    v_mfma_f32_16x16x32_bf16 v[92:95], a[32:35], v[36:39], v[92:95]
    v_mfma_f32_16x16x32_bf16 v[104:107], a[32:35], v[40:43], 0
    v_mfma_f32_16x16x32_bf16 v[104:107], a[20:23], v[36:39], v[104:107]
    v_mfma_f32_16x16x32_bf16 v[104:107], a[8:11], v[32:35], v[104:107]
    v_mfma_f32_16x16x32_bf16 v[116:119], a[8:11], v[36:39], 0
    v_mfma_f32_16x16x32_bf16 v[116:119], a[20:23], v[40:43], v[116:119]
    v_mfma_f32_16x16x32_bf16 v[116:119], a[32:35], v[44:47], v[116:119]
    s_waitcnt lgkmcnt(1)
    v_mfma_f32_16x16x32_bf16 v[116:119], a[44:47], v[192:195], v[116:119]
    v_mfma_f32_16x16x32_bf16 v[116:119], a[56:59], v[196:199], v[116:119]
    v_mfma_f32_16x16x32_bf16 v[116:119], a[68:71], v[200:203], v[116:119]
    v_mfma_f32_16x16x32_bf16 v[104:107], a[68:71], v[196:199], v[104:107]
    v_mfma_f32_16x16x32_bf16 v[104:107], a[56:59], v[192:195], v[104:107]
    v_mfma_f32_16x16x32_bf16 v[104:107], a[44:47], v[16:19], v[104:107]
    s_waitcnt lgkmcnt(0)
    v_mfma_f32_16x16x32_bf16 v[92:95], a[44:47], v[20:23], v[92:95]
    v_mfma_f32_16x16x32_bf16 v[92:95], a[56:59], v[16:19], v[92:95]
    v_mfma_f32_16x16x32_bf16 v[92:95], a[68:71], v[192:195], v[92:95]
    v_mfma_f32_16x16x32_bf16 v[88:91], a[64:67], v[192:195], v[88:91]
    v_mfma_f32_16x16x32_bf16 v[88:91], a[52:55], v[16:19], v[88:91]
    v_mfma_f32_16x16x32_bf16 v[88:91], a[40:43], v[20:23], v[88:91]
    v_mfma_f32_16x16x32_bf16 v[100:103], a[40:43], v[16:19], v[100:103]
    ds_read_b128 v[24:27], v7 offset:20992
    v_mfma_f32_16x16x32_bf16 v[100:103], a[52:55], v[192:195], v[100:103]
    ds_read_b128 v[28:31], v8 offset:24064
    v_mfma_f32_16x16x32_bf16 v[100:103], a[64:67], v[196:199], v[100:103]
    ds_read_b128 v[32:35], v9 offset:27136
    v_mfma_f32_16x16x32_bf16 v[112:115], a[64:67], v[200:203], v[112:115]
    ds_read_b128 v[36:39], v8 offset:20992
    v_mfma_f32_16x16x32_bf16 v[112:115], a[52:55], v[196:199], v[112:115]
    v_mfma_f32_16x16x32_bf16 v[112:115], a[40:43], v[192:195], v[112:115]
    v_mfma_f32_16x16x32_bf16 v[108:111], a[36:39], v[192:195], v[108:111]
    ds_read_b128 v[40:43], v9 offset:24064
    v_mfma_f32_16x16x32_bf16 v[108:111], a[48:51], v[196:199], v[108:111]
    v_mfma_f32_16x16x32_bf16 v[108:111], a[60:63], v[200:203], v[108:111]
    v_mfma_f32_16x16x32_bf16 v[96:99], a[60:63], v[196:199], v[96:99]
    v_mfma_f32_16x16x32_bf16 v[96:99], a[48:51], v[192:195], v[96:99]
    v_mfma_f32_16x16x32_bf16 v[96:99], a[36:39], v[16:19], v[96:99]
    v_mfma_f32_16x16x32_bf16 v[84:87], a[36:39], v[20:23], v[84:87]
    v_mfma_f32_16x16x32_bf16 v[84:87], a[48:51], v[16:19], v[84:87]
    v_mfma_f32_16x16x32_bf16 v[84:87], a[60:63], v[192:195], v[84:87]
    s_waitcnt lgkmcnt(1)
    v_mfma_f32_16x16x32_bf16 v[84:87], a[72:75], v[24:27], v[84:87]
    v_mfma_f32_16x16x32_bf16 v[84:87], a[84:87], v[28:31], v[84:87]
    v_mfma_f32_16x16x32_bf16 v[84:87], a[96:99], v[32:35], v[84:87]
    v_mfma_f32_16x16x32_bf16 v[96:99], a[96:99], v[36:39], v[96:99]
    v_mfma_f32_16x16x32_bf16 v[96:99], a[84:87], v[32:35], v[96:99]
    v_mfma_f32_16x16x32_bf16 v[96:99], a[72:75], v[28:31], v[96:99]
    s_waitcnt lgkmcnt(0)
    v_mfma_f32_16x16x32_bf16 v[108:111], a[72:75], v[32:35], v[108:111]
    v_mfma_f32_16x16x32_bf16 v[108:111], a[84:87], v[36:39], v[108:111]
    v_mfma_f32_16x16x32_bf16 v[108:111], a[96:99], v[40:43], v[108:111]
    v_mfma_f32_16x16x32_bf16 v[112:115], a[100:103], v[40:43], v[112:115]
    s_add_u32 m0, s27, 125952
    v_mfma_f32_16x16x32_bf16 v[112:115], a[88:91], v[36:39], v[112:115]
    buffer_load_dwordx4 v5, s[4:7], s26 offen nt lds
    v_mfma_f32_16x16x32_bf16 v[112:115], a[76:79], v[32:35], v[112:115]
    s_waitcnt vmcnt(19)
    s_barrier
    v_mfma_f32_16x16x32_bf16 v[100:103], a[76:79], v[28:31], v[100:103]
    ds_read_b128 v[44:47], v9 offset:36864
    ds_read_b128 v[212:215], v208 offset:0
    v_mfma_f32_16x16x32_bf16 v[100:103], a[88:91], v[32:35], v[100:103]
    ds_read_b128 v[192:195], v8 offset:30720
    ds_read_b128 v[216:219], v209 offset:0
    v_mfma_f32_16x16x32_bf16 v[100:103], a[100:103], v[36:39], v[100:103]
    ds_read_b128 v[196:199], v9 offset:33792
    ds_read_b128 v[220:223], v210 offset:0
    v_mfma_f32_16x16x32_bf16 v[88:91], a[100:103], v[32:35], v[88:91]
    ds_read_b128 v[200:203], v8 offset:33792
    ds_read_b128 v[224:227], v232 offset:0
    v_mfma_f32_16x16x32_bf16 v[88:91], a[88:91], v[28:31], v[88:91]
    ds_read_b128 v[228:231], v233 offset:0
    v_mfma_f32_16x16x32_bf16 v[88:91], a[76:79], v[24:27], v[88:91]
    v_mfma_f32_16x16x32_bf16 v[92:95], a[80:83], v[24:27], v[92:95]
    ds_read_b128 v[16:19], v7 offset:30720
    s_waitcnt lgkmcnt(8)
    v_mfma_f32_16x16x32_bf16 v[92:95], a[92:95], v[28:31], v[92:95]
    buffer_store_dwordx4 v[212:215], v15, s[12:15], s33 offen offset:0 nt
    v_mfma_f32_16x16x32_bf16 v[92:95], a[104:107], v[32:35], v[92:95]
    s_waitcnt lgkmcnt(6)
    v_mfma_f32_16x16x32_bf16 v[104:107], a[104:107], v[36:39], v[104:107]
    v_mfma_f32_16x16x32_bf16 v[104:107], a[92:95], v[32:35], v[104:107]
    v_mfma_f32_16x16x32_bf16 v[104:107], a[80:83], v[28:31], v[104:107]
    v_mfma_f32_16x16x32_bf16 v[116:119], a[80:83], v[32:35], v[116:119]
    v_mfma_f32_16x16x32_bf16 v[116:119], a[92:95], v[36:39], v[116:119]
    v_mfma_f32_16x16x32_bf16 v[116:119], a[104:107], v[40:43], v[116:119]
    s_waitcnt lgkmcnt(3)
    v_mfma_f32_16x16x32_bf16 v[116:119], a[116:119], v[44:47], v[116:119]
    v_mfma_f32_16x16x32_bf16 v[116:119], a[128:131], v[192:195], v[116:119]
    v_mfma_f32_16x16x32_bf16 v[116:119], a[140:143], v[196:199], v[116:119]
    v_mfma_f32_16x16x32_bf16 v[104:107], a[140:143], v[192:195], v[104:107]
    v_mfma_f32_16x16x32_bf16 v[104:107], a[128:131], v[44:47], v[104:107]
    buffer_store_dwordx4 v[216:219], v15, s[12:15], s33 offen offset:1024 nt
    v_mfma_f32_16x16x32_bf16 v[104:107], a[116:119], v[200:203], v[104:107]
    s_waitcnt lgkmcnt(0)
    v_mfma_f32_16x16x32_bf16 v[92:95], a[116:119], v[16:19], v[92:95]
    v_mfma_f32_16x16x32_bf16 v[92:95], a[128:131], v[200:203], v[92:95]
    v_mfma_f32_16x16x32_bf16 v[92:95], a[140:143], v[44:47], v[92:95]
    v_mfma_f32_16x16x32_bf16 v[88:91], a[136:139], v[44:47], v[88:91]
    v_mfma_f32_16x16x32_bf16 v[88:91], a[124:127], v[200:203], v[88:91]
    v_mfma_f32_16x16x32_bf16 v[88:91], a[112:115], v[16:19], v[88:91]
    v_mfma_f32_16x16x32_bf16 v[100:103], a[112:115], v[200:203], v[100:103]
    ds_read_b128 v[20:23], v7 offset:30976
    v_mfma_f32_16x16x32_bf16 v[100:103], a[124:127], v[44:47], v[100:103]
    ds_read_b128 v[24:27], v8 offset:34048
    v_mfma_f32_16x16x32_bf16 v[100:103], a[136:139], v[192:195], v[100:103]
    ds_read_b128 v[28:31], v9 offset:37120
    v_mfma_f32_16x16x32_bf16 v[112:115], a[136:139], v[196:199], v[112:115]
    ds_read_b128 v[32:35], v8 offset:30976
    v_mfma_f32_16x16x32_bf16 v[112:115], a[124:127], v[192:195], v[112:115]
    buffer_store_dwordx4 v[220:223], v15, s[12:15], s33 offen offset:2048 nt
    v_mfma_f32_16x16x32_bf16 v[112:115], a[112:115], v[44:47], v[112:115]
    v_mfma_f32_16x16x32_bf16 v[108:111], a[108:111], v[44:47], v[108:111]
    ds_read_b128 v[36:39], v9 offset:34048
    v_mfma_f32_16x16x32_bf16 v[108:111], a[120:123], v[192:195], v[108:111]
    v_mfma_f32_16x16x32_bf16 v[108:111], a[132:135], v[196:199], v[108:111]
    v_mfma_f32_16x16x32_bf16 v[96:99], a[132:135], v[192:195], v[96:99]
    v_mfma_f32_16x16x32_bf16 v[96:99], a[120:123], v[44:47], v[96:99]
    v_mfma_f32_16x16x32_bf16 v[96:99], a[108:111], v[200:203], v[96:99]
    v_mfma_f32_16x16x32_bf16 v[84:87], a[108:111], v[16:19], v[84:87]
    v_mfma_f32_16x16x32_bf16 v[84:87], a[120:123], v[200:203], v[84:87]
    v_mfma_f32_16x16x32_bf16 v[84:87], a[132:135], v[44:47], v[84:87]
    s_waitcnt lgkmcnt(1)
    v_mfma_f32_16x16x32_bf16 v[84:87], a[144:147], v[20:23], v[84:87]
    v_mfma_f32_16x16x32_bf16 v[84:87], a[156:159], v[24:27], v[84:87]
    buffer_store_dwordx4 v[224:227], v15, s[12:15], s33 offen offset:3072 nt
    v_mfma_f32_16x16x32_bf16 v[84:87], a[168:171], v[28:31], v[84:87]
    v_mfma_f32_16x16x32_bf16 v[96:99], a[168:171], v[32:35], v[96:99]
    v_mfma_f32_16x16x32_bf16 v[96:99], a[156:159], v[28:31], v[96:99]
    v_mfma_f32_16x16x32_bf16 v[96:99], a[144:147], v[24:27], v[96:99]
    s_waitcnt lgkmcnt(0)
    v_mfma_f32_16x16x32_bf16 v[108:111], a[144:147], v[28:31], v[108:111]
    v_mfma_f32_16x16x32_bf16 v[108:111], a[156:159], v[32:35], v[108:111]
    v_mfma_f32_16x16x32_bf16 v[108:111], a[168:171], v[36:39], v[108:111]
    v_mfma_f32_16x16x32_bf16 v[112:115], a[172:175], v[36:39], v[112:115]
    v_mfma_f32_16x16x32_bf16 v[112:115], a[160:163], v[32:35], v[112:115]
    v_mfma_f32_16x16x32_bf16 v[112:115], a[148:151], v[28:31], v[112:115]
    v_mfma_f32_16x16x32_bf16 v[100:103], a[148:151], v[24:27], v[100:103]
    ds_read_b128 v[40:43], v9 offset:37376
    v_mfma_f32_16x16x32_bf16 v[100:103], a[160:163], v[28:31], v[100:103]
    ds_read_b128 v[44:47], v8 offset:31232
    v_mfma_f32_16x16x32_bf16 v[100:103], a[172:175], v[32:35], v[100:103]
    ds_read_b128 v[192:195], v9 offset:34304
    v_mfma_f32_16x16x32_bf16 v[88:91], a[172:175], v[28:31], v[88:91]
    ds_read_b128 v[196:199], v8 offset:34304
    v_mfma_f32_16x16x32_bf16 v[88:91], a[160:163], v[24:27], v[88:91]
    buffer_store_dwordx4 v[228:231], v188, s[12:15], s33 offen nt
    s_add_u32 s33, s33, s44
    v_mfma_f32_16x16x32_bf16 v[88:91], a[148:151], v[20:23], v[88:91]
    v_mfma_f32_16x16x32_bf16 v[92:95], a[152:155], v[20:23], v[92:95]
    ds_read_b128 v[200:203], v7 offset:31232
    v_mfma_f32_16x16x32_bf16 v[92:95], a[164:167], v[24:27], v[92:95]
    v_mfma_f32_16x16x32_bf16 v[92:95], a[176:179], v[28:31], v[92:95]
    v_mfma_f32_16x16x32_bf16 v[104:107], a[176:179], v[32:35], v[104:107]
    v_mfma_f32_16x16x32_bf16 v[104:107], a[164:167], v[28:31], v[104:107]
    v_mfma_f32_16x16x32_bf16 v[104:107], a[152:155], v[24:27], v[104:107]
    v_mfma_f32_16x16x32_bf16 v[116:119], a[152:155], v[28:31], v[116:119]
    v_mfma_f32_16x16x32_bf16 v[116:119], a[164:167], v[32:35], v[116:119]
    v_mfma_f32_16x16x32_bf16 v[116:119], a[176:179], v[36:39], v[116:119]
    s_waitcnt lgkmcnt(1)
    v_mfma_f32_16x16x32_bf16 v[116:119], a[188:191], v[40:43], v[116:119]
    v_mfma_f32_16x16x32_bf16 v[116:119], a[200:203], v[44:47], v[116:119]
    v_mfma_f32_16x16x32_bf16 v[116:119], a[212:215], v[192:195], v[116:119]
    v_mfma_f32_16x16x32_bf16 v[104:107], a[212:215], v[44:47], v[104:107]
    v_mfma_f32_16x16x32_bf16 v[104:107], a[200:203], v[40:43], v[104:107]
    v_mfma_f32_16x16x32_bf16 v[104:107], a[188:191], v[196:199], v[104:107]
    s_waitcnt lgkmcnt(0)
    v_mfma_f32_16x16x32_bf16 v[92:95], a[188:191], v[200:203], v[92:95]
    v_mfma_f32_16x16x32_bf16 v[92:95], a[200:203], v[196:199], v[92:95]
    v_mfma_f32_16x16x32_bf16 v[92:95], a[212:215], v[40:43], v[92:95]
    v_mfma_f32_16x16x32_bf16 v[88:91], a[208:211], v[40:43], v[88:91]
    v_mfma_f32_16x16x32_bf16 v[88:91], a[196:199], v[196:199], v[88:91]
    v_mfma_f32_16x16x32_bf16 v[88:91], a[184:187], v[200:203], v[88:91]
    v_mfma_f32_16x16x32_bf16 v[100:103], a[184:187], v[196:199], v[100:103]
    ds_read_b128 v[16:19], v7 offset:40960
    v_mfma_f32_16x16x32_bf16 v[100:103], a[196:199], v[40:43], v[100:103]
    ds_read_b128 v[20:23], v8 offset:44032
    v_mfma_f32_16x16x32_bf16 v[100:103], a[208:211], v[44:47], v[100:103]
    ds_read_b128 v[24:27], v9 offset:47104
    v_mfma_f32_16x16x32_bf16 v[112:115], a[208:211], v[192:195], v[112:115]
    ds_read_b128 v[28:31], v8 offset:40960
    v_mfma_f32_16x16x32_bf16 v[112:115], a[196:199], v[44:47], v[112:115]
    v_mfma_f32_16x16x32_bf16 v[112:115], a[184:187], v[40:43], v[112:115]
    v_mfma_f32_16x16x32_bf16 v[108:111], a[180:183], v[40:43], v[108:111]
    ds_read_b128 v[32:35], v9 offset:44032
    v_mfma_f32_16x16x32_bf16 v[108:111], a[192:195], v[44:47], v[108:111]
    v_mfma_f32_16x16x32_bf16 v[108:111], a[204:207], v[192:195], v[108:111]
    v_mfma_f32_16x16x32_bf16 v[96:99], a[204:207], v[44:47], v[96:99]
    v_mfma_f32_16x16x32_bf16 v[96:99], a[192:195], v[40:43], v[96:99]
    v_mfma_f32_16x16x32_bf16 v[96:99], a[180:183], v[196:199], v[96:99]
    v_mfma_f32_16x16x32_bf16 v[84:87], a[180:183], v[200:203], v[84:87]
    v_mfma_f32_16x16x32_bf16 v[84:87], a[192:195], v[196:199], v[84:87]
    v_mfma_f32_16x16x32_bf16 v[84:87], a[204:207], v[40:43], v[84:87]
    s_waitcnt lgkmcnt(1)
    v_mfma_f32_16x16x32_bf16 v[84:87], a[216:219], v[16:19], v[84:87]
    v_mfma_f32_16x16x32_bf16 v[84:87], a[228:231], v[20:23], v[84:87]
    v_mfma_f32_16x16x32_bf16 v[84:87], a[240:243], v[24:27], v[84:87]
    v_mfma_f32_16x16x32_bf16 v[96:99], a[240:243], v[28:31], v[96:99]
    v_mfma_f32_16x16x32_bf16 v[96:99], a[228:231], v[24:27], v[96:99]
    v_mfma_f32_16x16x32_bf16 v[96:99], a[216:219], v[20:23], v[96:99]
    s_waitcnt lgkmcnt(0)
    v_mfma_f32_16x16x32_bf16 v[108:111], a[216:219], v[24:27], v[108:111]
    v_mfma_f32_16x16x32_bf16 v[108:111], a[228:231], v[28:31], v[108:111]
    v_mfma_f32_16x16x32_bf16 v[108:111], a[240:243], v[32:35], v[108:111]
    v_mfma_f32_16x16x32_bf16 v[112:115], a[244:247], v[32:35], v[112:115]
    v_mfma_f32_16x16x32_bf16 v[112:115], a[232:235], v[28:31], v[112:115]
    v_mfma_f32_16x16x32_bf16 v[112:115], a[220:223], v[24:27], v[112:115]
    v_mfma_f32_16x16x32_bf16 v[100:103], a[220:223], v[20:23], v[100:103]
    ds_read_b128 v[36:39], v9 offset:47360
    v_mfma_f32_16x16x32_bf16 v[100:103], a[232:235], v[24:27], v[100:103]
    ds_read_b128 v[40:43], v8 offset:41216
    v_mfma_f32_16x16x32_bf16 v[100:103], a[244:247], v[28:31], v[100:103]
    ds_read_b128 v[44:47], v9 offset:44288
    v_mfma_f32_16x16x32_bf16 v[88:91], a[244:247], v[24:27], v[88:91]
    ds_read_b128 v[192:195], v8 offset:44288
    v_mfma_f32_16x16x32_bf16 v[88:91], a[232:235], v[20:23], v[88:91]
    v_mfma_f32_16x16x32_bf16 v[88:91], a[220:223], v[16:19], v[88:91]
    v_mfma_f32_16x16x32_bf16 v[92:95], a[224:227], v[16:19], v[92:95]
    ds_read_b128 v[196:199], v7 offset:41216
    v_mfma_f32_16x16x32_bf16 v[92:95], a[236:239], v[20:23], v[92:95]
    v_mfma_f32_16x16x32_bf16 v[92:95], a[248:251], v[24:27], v[92:95]
    v_mfma_f32_16x16x32_bf16 v[104:107], a[248:251], v[28:31], v[104:107]
    v_mfma_f32_16x16x32_bf16 v[104:107], a[236:239], v[24:27], v[104:107]
    s_add_u32 m0, s27, 126976
    v_mfma_f32_16x16x32_bf16 v[104:107], a[224:227], v[20:23], v[104:107]
    v_mfma_f32_16x16x32_bf16 v[116:119], a[224:227], v[24:27], v[116:119]
    v_mfma_f32_16x16x32_bf16 v[116:119], a[236:239], v[28:31], v[116:119]
    buffer_load_dwordx4 v6, s[4:7], s26 offen nt lds
    v_mfma_f32_16x16x32_bf16 v[116:119], a[248:251], v[32:35], v[116:119]
    s_waitcnt lgkmcnt(1)
    v_mfma_f32_16x16x32_bf16 v[116:119], v[124:127], v[36:39], v[116:119]
    v_mfma_f32_16x16x32_bf16 v[116:119], v[136:139], v[40:43], v[116:119]
    v_mfma_f32_16x16x32_bf16 v[116:119], v[148:151], v[44:47], v[116:119]
    v_mfma_f32_16x16x32_bf16 v[104:107], v[148:151], v[40:43], v[104:107]
    v_mfma_f32_16x16x32_bf16 v[104:107], v[136:139], v[36:39], v[104:107]
    v_mfma_f32_16x16x32_bf16 v[104:107], v[124:127], v[192:195], v[104:107]
    s_waitcnt lgkmcnt(0)
    v_mfma_f32_16x16x32_bf16 v[92:95], v[124:127], v[196:199], v[92:95]
    v_mfma_f32_16x16x32_bf16 v[92:95], v[136:139], v[192:195], v[92:95]
    v_mfma_f32_16x16x32_bf16 v[92:95], v[148:151], v[36:39], v[92:95]
    v_mfma_f32_16x16x32_bf16 v[88:91], v[144:147], v[36:39], v[88:91]
    v_mfma_f32_16x16x32_bf16 v[88:91], v[132:135], v[192:195], v[88:91]
    v_mfma_f32_16x16x32_bf16 v[88:91], v[120:123], v[196:199], v[88:91]
    v_mfma_f32_16x16x32_bf16 v[100:103], v[120:123], v[192:195], v[100:103]
    ds_read_b128 v[200:203], v7 offset:41472
    v_mfma_f32_16x16x32_bf16 v[100:103], v[132:135], v[36:39], v[100:103]
    ds_read_b128 v[16:19], v8 offset:44544
    v_mfma_f32_16x16x32_bf16 v[100:103], v[144:147], v[40:43], v[100:103]
    ds_read_b128 v[20:23], v9 offset:47616
    v_mfma_f32_16x16x32_bf16 v[112:115], v[144:147], v[44:47], v[112:115]
    v_mfma_f32_16x16x32_bf16 v[112:115], v[132:135], v[40:43], v[112:115]
    v_mfma_f32_16x16x32_bf16 v[112:115], v[120:123], v[36:39], v[112:115]
    v_mfma_f32_16x16x32_bf16 v[108:111], a[252:255], v[36:39], v[108:111]
    v_mfma_f32_16x16x32_bf16 v[108:111], v[128:131], v[40:43], v[108:111]
    v_mfma_f32_16x16x32_bf16 v[108:111], v[140:143], v[44:47], v[108:111]
    v_mfma_f32_16x16x32_bf16 v[96:99], v[140:143], v[40:43], v[96:99]
    ds_read_b128 v[24:27], v8 offset:41472
    v_mfma_f32_16x16x32_bf16 v[96:99], v[128:131], v[36:39], v[96:99]
    v_mfma_f32_16x16x32_bf16 v[96:99], a[252:255], v[192:195], v[96:99]
    v_mfma_f32_16x16x32_bf16 v[84:87], a[252:255], v[196:199], v[84:87]
    v_mfma_f32_16x16x32_bf16 v[84:87], v[128:131], v[192:195], v[84:87]
    v_mfma_f32_16x16x32_bf16 v[84:87], v[140:143], v[36:39], v[84:87]
    s_waitcnt lgkmcnt(1)
    v_mfma_f32_16x16x32_bf16 v[84:87], v[152:155], v[200:203], v[84:87]
    v_mfma_f32_16x16x32_bf16 v[84:87], v[164:167], v[16:19], v[84:87]
    v_mfma_f32_16x16x32_bf16 v[84:87], v[176:179], v[20:23], v[84:87]
    v_mfma_f32_16x16x32_bf16 v[88:91], v[180:183], v[20:23], v[88:91]
    ds_read_b128 v[28:31], v9 offset:44544
    v_mfma_f32_16x16x32_bf16 v[88:91], v[168:171], v[16:19], v[88:91]
    v_mfma_f32_16x16x32_bf16 v[88:91], v[156:159], v[200:203], v[88:91]
    v_mfma_f32_16x16x32_bf16 v[92:95], v[160:163], v[200:203], v[92:95]
    v_mfma_f32_16x16x32_bf16 v[92:95], v[172:175], v[16:19], v[92:95]
    v_mfma_f32_16x16x32_bf16 v[92:95], v[184:187], v[20:23], v[92:95]
    s_waitcnt lgkmcnt(1)
    v_mfma_f32_16x16x32_bf16 v[104:107], v[184:187], v[24:27], v[104:107]
    v_mfma_f32_16x16x32_bf16 v[104:107], v[172:175], v[20:23], v[104:107]
    v_mfma_f32_16x16x32_bf16 v[104:107], v[160:163], v[16:19], v[104:107]
    v_mfma_f32_16x16x32_bf16 v[100:103], v[156:159], v[16:19], v[100:103]
    v_add_u32 v7, 40960, v7
    v_add_u32 v8, 40960, v8
    v_add_u32 v9, 40960, v9
    ds_read_b128 v[32:35], v7 offset:0
    v_mfma_f32_16x16x32_bf16 v[100:103], v[168:171], v[20:23], v[100:103]
    ds_read_b128 v[36:39], v8 offset:3072
    v_mfma_f32_16x16x32_bf16 v[100:103], v[180:183], v[24:27], v[100:103]
    ds_read_b128 v[40:43], v9 offset:6144
    v_mfma_f32_16x16x32_bf16 v[96:99], v[176:179], v[24:27], v[96:99]
    ds_read_b128 v[44:47], v8 offset:0
    v_cvt_pk_bf16_f32 v84, v84, v85
    v_mfma_f32_16x16x32_bf16 v[96:99], v[164:167], v[20:23], v[96:99]
    v_cvt_pk_bf16_f32 v85, v86, v87
    v_cvt_pk_bf16_f32 v86, v88, v89
    v_mfma_f32_16x16x32_bf16 v[96:99], v[152:155], v[16:19], v[96:99]
    v_cvt_pk_bf16_f32 v87, v90, v91
    s_waitcnt lgkmcnt(4)
    v_mfma_f32_16x16x32_bf16 v[108:111], v[152:155], v[20:23], v[108:111]
    ds_read_b128 v[192:195], v9 offset:3072
    ds_write_b128 v206, v[84:87] offset:20480
    v_mfma_f32_16x16x32_bf16 v[108:111], v[164:167], v[24:27], v[108:111]
    v_cvt_pk_bf16_f32 v92, v92, v93
    v_cvt_pk_bf16_f32 v93, v94, v95
    v_mfma_f32_16x16x32_bf16 v[108:111], v[176:179], v[28:31], v[108:111]
    ds_write_b64 v207, v[92:93] offset:20480
    v_mfma_f32_16x16x32_bf16 v[112:115], v[180:183], v[28:31], v[112:115]
    v_mfma_f32_16x16x32_bf16 v[112:115], v[168:171], v[24:27], v[112:115]
    v_mfma_f32_16x16x32_bf16 v[112:115], v[156:159], v[20:23], v[112:115]
    v_mfma_f32_16x16x32_bf16 v[116:119], v[160:163], v[20:23], v[116:119]
    v_cvt_pk_bf16_f32 v96, v96, v97
    v_cvt_pk_bf16_f32 v97, v98, v99
    v_mfma_f32_16x16x32_bf16 v[116:119], v[172:175], v[24:27], v[116:119]
    v_cvt_pk_bf16_f32 v98, v100, v101
    v_cvt_pk_bf16_f32 v99, v102, v103
    v_mfma_f32_16x16x32_bf16 v[116:119], v[184:187], v[28:31], v[116:119]
    ds_write_b128 v206, v[96:99] offset:23680
    s_waitcnt lgkmcnt(4)
    v_mfma_f32_16x16x32_bf16 v[48:51], a[0:3], v[32:35], 0
    v_cvt_pk_bf16_f32 v104, v104, v105
    v_cvt_pk_bf16_f32 v105, v106, v107
    v_mfma_f32_16x16x32_bf16 v[48:51], a[12:15], v[36:39], v[48:51]
    ds_write_b64 v207, v[104:105] offset:23680
    v_mfma_f32_16x16x32_bf16 v[48:51], a[24:27], v[40:43], v[48:51]
    v_mfma_f32_16x16x32_bf16 v[60:63], a[24:27], v[44:47], 0
    v_mfma_f32_16x16x32_bf16 v[60:63], a[12:15], v[40:43], v[60:63]
    v_mfma_f32_16x16x32_bf16 v[60:63], a[0:3], v[36:39], v[60:63]
    s_waitcnt lgkmcnt(4)
    v_mfma_f32_16x16x32_bf16 v[72:75], a[0:3], v[40:43], 0
    v_cvt_pk_bf16_f32 v108, v108, v109
    v_cvt_pk_bf16_f32 v109, v110, v111
    v_mfma_f32_16x16x32_bf16 v[72:75], a[12:15], v[44:47], v[72:75]
    v_cvt_pk_bf16_f32 v110, v112, v113
    v_cvt_pk_bf16_f32 v111, v114, v115
    v_mfma_f32_16x16x32_bf16 v[72:75], a[24:27], v[192:195], v[72:75]
    ds_write_b128 v206, v[108:111] offset:26880
    v_cvt_pk_bf16_f32 v116, v116, v117
    v_mfma_f32_16x16x32_bf16 v[76:79], a[28:31], v[192:195], 0
    v_cvt_pk_bf16_f32 v117, v118, v119
    ds_write_b64 v207, v[116:117] offset:26880
    v_mfma_f32_16x16x32_bf16 v[76:79], a[16:19], v[44:47], v[76:79]
    v_mfma_f32_16x16x32_bf16 v[76:79], a[4:7], v[40:43], v[76:79]
    v_mfma_f32_16x16x32_bf16 v[64:67], a[4:7], v[36:39], 0
    ds_read_b128 v[196:199], v9 offset:6400
    v_mfma_f32_16x16x32_bf16 v[64:67], a[16:19], v[40:43], v[64:67]
    ds_read_b128 v[200:203], v8 offset:256
    v_mfma_f32_16x16x32_bf16 v[64:67], a[28:31], v[44:47], v[64:67]
    ds_read_b128 v[16:19], v9 offset:3328
    v_mfma_f32_16x16x32_bf16 v[52:55], a[28:31], v[40:43], 0
    ds_read_b128 v[20:23], v8 offset:3328
    v_mfma_f32_16x16x32_bf16 v[52:55], a[16:19], v[36:39], v[52:55]
    v_mfma_f32_16x16x32_bf16 v[52:55], a[4:7], v[32:35], v[52:55]
    v_mfma_f32_16x16x32_bf16 v[56:59], a[8:11], v[32:35], 0
    ds_read_b128 v[24:27], v7 offset:256
    v_mfma_f32_16x16x32_bf16 v[56:59], a[20:23], v[36:39], v[56:59]
    v_mfma_f32_16x16x32_bf16 v[56:59], a[32:35], v[40:43], v[56:59]
    v_mfma_f32_16x16x32_bf16 v[68:71], a[32:35], v[44:47], 0
    v_mfma_f32_16x16x32_bf16 v[68:71], a[20:23], v[40:43], v[68:71]
    v_mfma_f32_16x16x32_bf16 v[68:71], a[8:11], v[36:39], v[68:71]
    v_mfma_f32_16x16x32_bf16 v[80:83], a[8:11], v[40:43], 0
    v_mfma_f32_16x16x32_bf16 v[80:83], a[20:23], v[44:47], v[80:83]
    v_mfma_f32_16x16x32_bf16 v[80:83], a[32:35], v[192:195], v[80:83]
    s_waitcnt lgkmcnt(1)
    v_mfma_f32_16x16x32_bf16 v[80:83], a[44:47], v[196:199], v[80:83]
    v_mfma_f32_16x16x32_bf16 v[80:83], a[56:59], v[200:203], v[80:83]
    v_mfma_f32_16x16x32_bf16 v[80:83], a[68:71], v[16:19], v[80:83]
    v_mfma_f32_16x16x32_bf16 v[68:71], a[68:71], v[200:203], v[68:71]
    v_mfma_f32_16x16x32_bf16 v[68:71], a[56:59], v[196:199], v[68:71]
    v_mfma_f32_16x16x32_bf16 v[68:71], a[44:47], v[20:23], v[68:71]
    s_waitcnt lgkmcnt(0)
    v_mfma_f32_16x16x32_bf16 v[56:59], a[44:47], v[24:27], v[56:59]
    v_mfma_f32_16x16x32_bf16 v[56:59], a[56:59], v[20:23], v[56:59]
    v_mfma_f32_16x16x32_bf16 v[56:59], a[68:71], v[196:199], v[56:59]
    v_mfma_f32_16x16x32_bf16 v[52:55], a[64:67], v[196:199], v[52:55]
    v_mfma_f32_16x16x32_bf16 v[52:55], a[52:55], v[20:23], v[52:55]
    v_mfma_f32_16x16x32_bf16 v[52:55], a[40:43], v[24:27], v[52:55]
    v_mfma_f32_16x16x32_bf16 v[64:67], a[40:43], v[20:23], v[64:67]
    ds_read_b128 v[28:31], v7 offset:512
    v_mfma_f32_16x16x32_bf16 v[64:67], a[52:55], v[196:199], v[64:67]
    ds_read_b128 v[32:35], v8 offset:3584
    v_mfma_f32_16x16x32_bf16 v[64:67], a[64:67], v[200:203], v[64:67]
    ds_read_b128 v[36:39], v9 offset:6656
    v_mfma_f32_16x16x32_bf16 v[76:79], a[64:67], v[16:19], v[76:79]
    ds_read_b128 v[40:43], v8 offset:512
    v_mfma_f32_16x16x32_bf16 v[76:79], a[52:55], v[200:203], v[76:79]
    v_mfma_f32_16x16x32_bf16 v[76:79], a[40:43], v[196:199], v[76:79]
    v_mfma_f32_16x16x32_bf16 v[72:75], a[36:39], v[196:199], v[72:75]
    ds_read_b128 v[44:47], v9 offset:3584
    v_mfma_f32_16x16x32_bf16 v[72:75], a[48:51], v[200:203], v[72:75]
    v_mfma_f32_16x16x32_bf16 v[72:75], a[60:63], v[16:19], v[72:75]
    v_mfma_f32_16x16x32_bf16 v[60:63], a[60:63], v[200:203], v[60:63]
    v_mfma_f32_16x16x32_bf16 v[60:63], a[48:51], v[196:199], v[60:63]
    v_mfma_f32_16x16x32_bf16 v[60:63], a[36:39], v[20:23], v[60:63]
    v_mfma_f32_16x16x32_bf16 v[48:51], a[36:39], v[24:27], v[48:51]
    v_mfma_f32_16x16x32_bf16 v[48:51], a[48:51], v[20:23], v[48:51]
    v_mfma_f32_16x16x32_bf16 v[48:51], a[60:63], v[196:199], v[48:51]
    s_waitcnt lgkmcnt(1)
    v_mfma_f32_16x16x32_bf16 v[48:51], a[72:75], v[28:31], v[48:51]
    v_mfma_f32_16x16x32_bf16 v[48:51], a[84:87], v[32:35], v[48:51]
    v_mfma_f32_16x16x32_bf16 v[48:51], a[96:99], v[36:39], v[48:51]
    v_mfma_f32_16x16x32_bf16 v[60:63], a[96:99], v[40:43], v[60:63]
    v_mfma_f32_16x16x32_bf16 v[60:63], a[84:87], v[36:39], v[60:63]
    v_mfma_f32_16x16x32_bf16 v[60:63], a[72:75], v[32:35], v[60:63]
    s_waitcnt lgkmcnt(0)
    v_mfma_f32_16x16x32_bf16 v[72:75], a[72:75], v[36:39], v[72:75]
    v_mfma_f32_16x16x32_bf16 v[72:75], a[84:87], v[40:43], v[72:75]
    v_mfma_f32_16x16x32_bf16 v[72:75], a[96:99], v[44:47], v[72:75]
    v_mfma_f32_16x16x32_bf16 v[76:79], a[100:103], v[44:47], v[76:79]
    v_mfma_f32_16x16x32_bf16 v[76:79], a[88:91], v[40:43], v[76:79]
    v_mfma_f32_16x16x32_bf16 v[76:79], a[76:79], v[36:39], v[76:79]
    s_waitcnt vmcnt(10)
    s_barrier
    v_mfma_f32_16x16x32_bf16 v[64:67], a[76:79], v[32:35], v[64:67]
    ds_read_b128 v[192:195], v9 offset:16384
    ds_read_b128 v[212:215], v208 offset:20480
    v_mfma_f32_16x16x32_bf16 v[64:67], a[88:91], v[36:39], v[64:67]
    ds_read_b128 v[196:199], v8 offset:10240
    ds_read_b128 v[216:219], v209 offset:20480
    v_mfma_f32_16x16x32_bf16 v[64:67], a[100:103], v[40:43], v[64:67]
    ds_read_b128 v[200:203], v9 offset:13312
    ds_read_b128 v[220:223], v210 offset:20480
    v_mfma_f32_16x16x32_bf16 v[52:55], a[100:103], v[36:39], v[52:55]
    ds_read_b128 v[16:19], v8 offset:13312
    ds_read_b128 v[224:227], v232 offset:20480
    v_mfma_f32_16x16x32_bf16 v[52:55], a[88:91], v[32:35], v[52:55]
    ds_read_b128 v[228:231], v233 offset:20480
    v_mfma_f32_16x16x32_bf16 v[52:55], a[76:79], v[28:31], v[52:55]
    v_mfma_f32_16x16x32_bf16 v[56:59], a[80:83], v[28:31], v[56:59]
    ds_read_b128 v[20:23], v7 offset:10240
    s_waitcnt lgkmcnt(8)
    v_mfma_f32_16x16x32_bf16 v[56:59], a[92:95], v[32:35], v[56:59]
    buffer_store_dwordx4 v[212:215], v15, s[12:15], s33 offen offset:0 nt
    v_mfma_f32_16x16x32_bf16 v[56:59], a[104:107], v[36:39], v[56:59]
    s_waitcnt lgkmcnt(6)
    v_mfma_f32_16x16x32_bf16 v[68:71], a[104:107], v[40:43], v[68:71]
    v_mfma_f32_16x16x32_bf16 v[68:71], a[92:95], v[36:39], v[68:71]
    v_mfma_f32_16x16x32_bf16 v[68:71], a[80:83], v[32:35], v[68:71]
    v_mfma_f32_16x16x32_bf16 v[80:83], a[80:83], v[36:39], v[80:83]
    v_mfma_f32_16x16x32_bf16 v[80:83], a[92:95], v[40:43], v[80:83]
    v_mfma_f32_16x16x32_bf16 v[80:83], a[104:107], v[44:47], v[80:83]
    s_waitcnt lgkmcnt(3)
    v_mfma_f32_16x16x32_bf16 v[80:83], a[116:119], v[192:195], v[80:83]
    v_mfma_f32_16x16x32_bf16 v[80:83], a[128:131], v[196:199], v[80:83]
    v_mfma_f32_16x16x32_bf16 v[80:83], a[140:143], v[200:203], v[80:83]
    v_mfma_f32_16x16x32_bf16 v[68:71], a[140:143], v[196:199], v[68:71]
    v_mfma_f32_16x16x32_bf16 v[68:71], a[128:131], v[192:195], v[68:71]
    buffer_store_dwordx4 v[216:219], v15, s[12:15], s33 offen offset:1024 nt
    v_mfma_f32_16x16x32_bf16 v[68:71], a[116:119], v[16:19], v[68:71]
    s_waitcnt lgkmcnt(0)
    v_mfma_f32_16x16x32_bf16 v[56:59], a[116:119], v[20:23], v[56:59]
    v_mfma_f32_16x16x32_bf16 v[56:59], a[128:131], v[16:19], v[56:59]
    v_mfma_f32_16x16x32_bf16 v[56:59], a[140:143], v[192:195], v[56:59]
    v_mfma_f32_16x16x32_bf16 v[52:55], a[136:139], v[192:195], v[52:55]
    v_mfma_f32_16x16x32_bf16 v[52:55], a[124:127], v[16:19], v[52:55]
    v_mfma_f32_16x16x32_bf16 v[52:55], a[112:115], v[20:23], v[52:55]
    v_mfma_f32_16x16x32_bf16 v[64:67], a[112:115], v[16:19], v[64:67]
    ds_read_b128 v[24:27], v7 offset:10496
    v_mfma_f32_16x16x32_bf16 v[64:67], a[124:127], v[192:195], v[64:67]
    ds_read_b128 v[28:31], v8 offset:13568
    v_mfma_f32_16x16x32_bf16 v[64:67], a[136:139], v[196:199], v[64:67]
    ds_read_b128 v[32:35], v9 offset:16640
    v_mfma_f32_16x16x32_bf16 v[76:79], a[136:139], v[200:203], v[76:79]
    ds_read_b128 v[36:39], v8 offset:10496
    v_mfma_f32_16x16x32_bf16 v[76:79], a[124:127], v[196:199], v[76:79]
    buffer_store_dwordx4 v[220:223], v15, s[12:15], s33 offen offset:2048 nt
    v_mfma_f32_16x16x32_bf16 v[76:79], a[112:115], v[192:195], v[76:79]
    v_mfma_f32_16x16x32_bf16 v[72:75], a[108:111], v[192:195], v[72:75]
    ds_read_b128 v[40:43], v9 offset:13568
    v_mfma_f32_16x16x32_bf16 v[72:75], a[120:123], v[196:199], v[72:75]
    v_mfma_f32_16x16x32_bf16 v[72:75], a[132:135], v[200:203], v[72:75]
    v_mfma_f32_16x16x32_bf16 v[60:63], a[132:135], v[196:199], v[60:63]
    v_mfma_f32_16x16x32_bf16 v[60:63], a[120:123], v[192:195], v[60:63]
    v_mfma_f32_16x16x32_bf16 v[60:63], a[108:111], v[16:19], v[60:63]
    v_mfma_f32_16x16x32_bf16 v[48:51], a[108:111], v[20:23], v[48:51]
    v_mfma_f32_16x16x32_bf16 v[48:51], a[120:123], v[16:19], v[48:51]
    v_mfma_f32_16x16x32_bf16 v[48:51], a[132:135], v[192:195], v[48:51]
    s_waitcnt lgkmcnt(1)
    v_mfma_f32_16x16x32_bf16 v[48:51], a[144:147], v[24:27], v[48:51]
    v_mfma_f32_16x16x32_bf16 v[48:51], a[156:159], v[28:31], v[48:51]
    buffer_store_dwordx4 v[224:227], v15, s[12:15], s33 offen offset:3072 nt
    v_mfma_f32_16x16x32_bf16 v[48:51], a[168:171], v[32:35], v[48:51]
    v_mfma_f32_16x16x32_bf16 v[60:63], a[168:171], v[36:39], v[60:63]
    v_mfma_f32_16x16x32_bf16 v[60:63], a[156:159], v[32:35], v[60:63]
    v_mfma_f32_16x16x32_bf16 v[60:63], a[144:147], v[28:31], v[60:63]
    s_waitcnt lgkmcnt(0)
    v_mfma_f32_16x16x32_bf16 v[72:75], a[144:147], v[32:35], v[72:75]
    v_mfma_f32_16x16x32_bf16 v[72:75], a[156:159], v[36:39], v[72:75]
    v_mfma_f32_16x16x32_bf16 v[72:75], a[168:171], v[40:43], v[72:75]
    v_mfma_f32_16x16x32_bf16 v[76:79], a[172:175], v[40:43], v[76:79]
    v_mfma_f32_16x16x32_bf16 v[76:79], a[160:163], v[36:39], v[76:79]
    v_mfma_f32_16x16x32_bf16 v[76:79], a[148:151], v[32:35], v[76:79]
    v_mfma_f32_16x16x32_bf16 v[64:67], a[148:151], v[28:31], v[64:67]
    ds_read_b128 v[44:47], v9 offset:16896
    v_mfma_f32_16x16x32_bf16 v[64:67], a[160:163], v[32:35], v[64:67]
    ds_read_b128 v[192:195], v8 offset:10752
    v_mfma_f32_16x16x32_bf16 v[64:67], a[172:175], v[36:39], v[64:67]
    ds_read_b128 v[196:199], v9 offset:13824
    v_mfma_f32_16x16x32_bf16 v[52:55], a[172:175], v[32:35], v[52:55]
    ds_read_b128 v[200:203], v8 offset:13824
    v_mfma_f32_16x16x32_bf16 v[52:55], a[160:163], v[28:31], v[52:55]
    buffer_store_dwordx4 v[228:231], v188, s[12:15], s33 offen nt
    s_add_u32 s33, s33, s44
    v_mfma_f32_16x16x32_bf16 v[52:55], a[148:151], v[24:27], v[52:55]
    v_mfma_f32_16x16x32_bf16 v[56:59], a[152:155], v[24:27], v[56:59]
    ds_read_b128 v[16:19], v7 offset:10752
    v_mfma_f32_16x16x32_bf16 v[56:59], a[164:167], v[28:31], v[56:59]
    v_mfma_f32_16x16x32_bf16 v[56:59], a[176:179], v[32:35], v[56:59]
    v_mfma_f32_16x16x32_bf16 v[68:71], a[176:179], v[36:39], v[68:71]
    v_mfma_f32_16x16x32_bf16 v[68:71], a[164:167], v[32:35], v[68:71]
    v_mfma_f32_16x16x32_bf16 v[68:71], a[152:155], v[28:31], v[68:71]
    v_mfma_f32_16x16x32_bf16 v[80:83], a[152:155], v[32:35], v[80:83]
    v_mfma_f32_16x16x32_bf16 v[80:83], a[164:167], v[36:39], v[80:83]
    v_mfma_f32_16x16x32_bf16 v[80:83], a[176:179], v[40:43], v[80:83]
    s_waitcnt lgkmcnt(1)
    v_mfma_f32_16x16x32_bf16 v[80:83], a[188:191], v[44:47], v[80:83]
    v_mfma_f32_16x16x32_bf16 v[80:83], a[200:203], v[192:195], v[80:83]
    v_mfma_f32_16x16x32_bf16 v[80:83], a[212:215], v[196:199], v[80:83]
    v_mfma_f32_16x16x32_bf16 v[68:71], a[212:215], v[192:195], v[68:71]
    v_mfma_f32_16x16x32_bf16 v[68:71], a[200:203], v[44:47], v[68:71]
    v_mfma_f32_16x16x32_bf16 v[68:71], a[188:191], v[200:203], v[68:71]
    s_waitcnt lgkmcnt(0)
    v_mfma_f32_16x16x32_bf16 v[56:59], a[188:191], v[16:19], v[56:59]
    v_mfma_f32_16x16x32_bf16 v[56:59], a[200:203], v[200:203], v[56:59]
    v_mfma_f32_16x16x32_bf16 v[56:59], a[212:215], v[44:47], v[56:59]
    v_mfma_f32_16x16x32_bf16 v[52:55], a[208:211], v[44:47], v[52:55]
    v_mfma_f32_16x16x32_bf16 v[52:55], a[196:199], v[200:203], v[52:55]
    v_mfma_f32_16x16x32_bf16 v[52:55], a[184:187], v[16:19], v[52:55]
    v_mfma_f32_16x16x32_bf16 v[64:67], a[184:187], v[200:203], v[64:67]
    ds_read_b128 v[20:23], v7 offset:20480
    v_mfma_f32_16x16x32_bf16 v[64:67], a[196:199], v[44:47], v[64:67]
    ds_read_b128 v[24:27], v8 offset:23552
    v_mfma_f32_16x16x32_bf16 v[64:67], a[208:211], v[192:195], v[64:67]
    ds_read_b128 v[28:31], v9 offset:26624
    v_mfma_f32_16x16x32_bf16 v[76:79], a[208:211], v[196:199], v[76:79]
    ds_read_b128 v[32:35], v8 offset:20480
    v_mfma_f32_16x16x32_bf16 v[76:79], a[196:199], v[192:195], v[76:79]
    v_mfma_f32_16x16x32_bf16 v[76:79], a[184:187], v[44:47], v[76:79]
    v_mfma_f32_16x16x32_bf16 v[72:75], a[180:183], v[44:47], v[72:75]
    ds_read_b128 v[36:39], v9 offset:23552
    v_mfma_f32_16x16x32_bf16 v[72:75], a[192:195], v[192:195], v[72:75]
    v_mfma_f32_16x16x32_bf16 v[72:75], a[204:207], v[196:199], v[72:75]
    v_mfma_f32_16x16x32_bf16 v[60:63], a[204:207], v[192:195], v[60:63]
    v_mfma_f32_16x16x32_bf16 v[60:63], a[192:195], v[44:47], v[60:63]
    v_mfma_f32_16x16x32_bf16 v[60:63], a[180:183], v[200:203], v[60:63]
    v_mfma_f32_16x16x32_bf16 v[48:51], a[180:183], v[16:19], v[48:51]
    v_mfma_f32_16x16x32_bf16 v[48:51], a[192:195], v[200:203], v[48:51]
    v_mfma_f32_16x16x32_bf16 v[48:51], a[204:207], v[44:47], v[48:51]
    s_waitcnt lgkmcnt(1)
    v_mfma_f32_16x16x32_bf16 v[48:51], a[216:219], v[20:23], v[48:51]
    v_mfma_f32_16x16x32_bf16 v[48:51], a[228:231], v[24:27], v[48:51]
    v_mfma_f32_16x16x32_bf16 v[48:51], a[240:243], v[28:31], v[48:51]
    v_mfma_f32_16x16x32_bf16 v[60:63], a[240:243], v[32:35], v[60:63]
    v_mfma_f32_16x16x32_bf16 v[60:63], a[228:231], v[28:31], v[60:63]
    v_mfma_f32_16x16x32_bf16 v[60:63], a[216:219], v[24:27], v[60:63]
    s_waitcnt lgkmcnt(0)
    v_mfma_f32_16x16x32_bf16 v[72:75], a[216:219], v[28:31], v[72:75]
    v_mfma_f32_16x16x32_bf16 v[72:75], a[228:231], v[32:35], v[72:75]
    v_mfma_f32_16x16x32_bf16 v[72:75], a[240:243], v[36:39], v[72:75]
    v_mfma_f32_16x16x32_bf16 v[76:79], a[244:247], v[36:39], v[76:79]
    v_mfma_f32_16x16x32_bf16 v[76:79], a[232:235], v[32:35], v[76:79]
    v_mfma_f32_16x16x32_bf16 v[76:79], a[220:223], v[28:31], v[76:79]
    v_mfma_f32_16x16x32_bf16 v[64:67], a[220:223], v[24:27], v[64:67]
    ds_read_b128 v[40:43], v9 offset:26880
    v_mfma_f32_16x16x32_bf16 v[64:67], a[232:235], v[28:31], v[64:67]
    ds_read_b128 v[44:47], v8 offset:20736
    v_mfma_f32_16x16x32_bf16 v[64:67], a[244:247], v[32:35], v[64:67]
    ds_read_b128 v[192:195], v9 offset:23808
    v_mfma_f32_16x16x32_bf16 v[52:55], a[244:247], v[28:31], v[52:55]
    ds_read_b128 v[196:199], v8 offset:23808
    v_mfma_f32_16x16x32_bf16 v[52:55], a[232:235], v[24:27], v[52:55]
    v_mfma_f32_16x16x32_bf16 v[52:55], a[220:223], v[20:23], v[52:55]
    v_mfma_f32_16x16x32_bf16 v[56:59], a[224:227], v[20:23], v[56:59]
    ds_read_b128 v[200:203], v7 offset:20736
    v_mfma_f32_16x16x32_bf16 v[56:59], a[236:239], v[24:27], v[56:59]
    v_mfma_f32_16x16x32_bf16 v[56:59], a[248:251], v[28:31], v[56:59]
    v_mfma_f32_16x16x32_bf16 v[68:71], a[248:251], v[32:35], v[68:71]
    v_mfma_f32_16x16x32_bf16 v[68:71], a[236:239], v[28:31], v[68:71]
    v_mfma_f32_16x16x32_bf16 v[68:71], a[224:227], v[24:27], v[68:71]
    v_mfma_f32_16x16x32_bf16 v[80:83], a[224:227], v[28:31], v[80:83]
    v_mfma_f32_16x16x32_bf16 v[80:83], a[236:239], v[32:35], v[80:83]
    v_mfma_f32_16x16x32_bf16 v[80:83], a[248:251], v[36:39], v[80:83]
    s_waitcnt lgkmcnt(1)
    v_mfma_f32_16x16x32_bf16 v[80:83], v[124:127], v[40:43], v[80:83]
    v_mfma_f32_16x16x32_bf16 v[80:83], v[136:139], v[44:47], v[80:83]
    v_mfma_f32_16x16x32_bf16 v[80:83], v[148:151], v[192:195], v[80:83]
    v_mfma_f32_16x16x32_bf16 v[68:71], v[148:151], v[44:47], v[68:71]
    v_mfma_f32_16x16x32_bf16 v[68:71], v[136:139], v[40:43], v[68:71]
    v_mfma_f32_16x16x32_bf16 v[68:71], v[124:127], v[196:199], v[68:71]
    s_waitcnt lgkmcnt(0)
    v_mfma_f32_16x16x32_bf16 v[56:59], v[124:127], v[200:203], v[56:59]
    v_mfma_f32_16x16x32_bf16 v[56:59], v[136:139], v[196:199], v[56:59]
    v_mfma_f32_16x16x32_bf16 v[56:59], v[148:151], v[40:43], v[56:59]
    v_mfma_f32_16x16x32_bf16 v[52:55], v[144:147], v[40:43], v[52:55]
    v_mfma_f32_16x16x32_bf16 v[52:55], v[132:135], v[196:199], v[52:55]
    v_mfma_f32_16x16x32_bf16 v[52:55], v[120:123], v[200:203], v[52:55]
    v_mfma_f32_16x16x32_bf16 v[64:67], v[120:123], v[196:199], v[64:67]
    ds_read_b128 v[16:19], v7 offset:20992
    v_mfma_f32_16x16x32_bf16 v[64:67], v[132:135], v[40:43], v[64:67]
    ds_read_b128 v[20:23], v8 offset:24064
    v_mfma_f32_16x16x32_bf16 v[64:67], v[144:147], v[44:47], v[64:67]
    ds_read_b128 v[24:27], v9 offset:27136
    v_mfma_f32_16x16x32_bf16 v[76:79], v[144:147], v[192:195], v[76:79]
    v_mfma_f32_16x16x32_bf16 v[76:79], v[132:135], v[44:47], v[76:79]
    v_mfma_f32_16x16x32_bf16 v[76:79], v[120:123], v[40:43], v[76:79]
    v_mfma_f32_16x16x32_bf16 v[72:75], a[252:255], v[40:43], v[72:75]
    v_mfma_f32_16x16x32_bf16 v[72:75], v[128:131], v[44:47], v[72:75]
    v_mfma_f32_16x16x32_bf16 v[72:75], v[140:143], v[192:195], v[72:75]
    v_mfma_f32_16x16x32_bf16 v[60:63], v[140:143], v[44:47], v[60:63]
    ds_read_b128 v[28:31], v8 offset:20992
    v_mfma_f32_16x16x32_bf16 v[60:63], v[128:131], v[40:43], v[60:63]
    v_mfma_f32_16x16x32_bf16 v[60:63], a[252:255], v[196:199], v[60:63]
    v_mfma_f32_16x16x32_bf16 v[48:51], a[252:255], v[200:203], v[48:51]
    v_mfma_f32_16x16x32_bf16 v[48:51], v[128:131], v[196:199], v[48:51]
    v_mfma_f32_16x16x32_bf16 v[48:51], v[140:143], v[40:43], v[48:51]
    s_waitcnt lgkmcnt(1)
    v_mfma_f32_16x16x32_bf16 v[48:51], v[152:155], v[16:19], v[48:51]
    v_mfma_f32_16x16x32_bf16 v[48:51], v[164:167], v[20:23], v[48:51]
    v_mfma_f32_16x16x32_bf16 v[48:51], v[176:179], v[24:27], v[48:51]
    v_mfma_f32_16x16x32_bf16 v[52:55], v[180:183], v[24:27], v[52:55]
    ds_read_b128 v[32:35], v9 offset:24064
    v_mfma_f32_16x16x32_bf16 v[52:55], v[168:171], v[20:23], v[52:55]
    v_mfma_f32_16x16x32_bf16 v[52:55], v[156:159], v[16:19], v[52:55]
    v_mfma_f32_16x16x32_bf16 v[56:59], v[160:163], v[16:19], v[56:59]
    v_mfma_f32_16x16x32_bf16 v[56:59], v[172:175], v[20:23], v[56:59]
    v_mfma_f32_16x16x32_bf16 v[56:59], v[184:187], v[24:27], v[56:59]
    s_waitcnt lgkmcnt(1)
    v_mfma_f32_16x16x32_bf16 v[68:71], v[184:187], v[28:31], v[68:71]
    v_mfma_f32_16x16x32_bf16 v[68:71], v[172:175], v[24:27], v[68:71]
    v_mfma_f32_16x16x32_bf16 v[68:71], v[160:163], v[20:23], v[68:71]
    v_mfma_f32_16x16x32_bf16 v[64:67], v[156:159], v[20:23], v[64:67]
    ds_read_b128 v[36:39], v7 offset:20480
    v_mfma_f32_16x16x32_bf16 v[64:67], v[168:171], v[24:27], v[64:67]
    ds_read_b128 v[40:43], v8 offset:23552
    v_mfma_f32_16x16x32_bf16 v[64:67], v[180:183], v[28:31], v[64:67]
    ds_read_b128 v[44:47], v9 offset:26624
    v_mfma_f32_16x16x32_bf16 v[60:63], v[176:179], v[28:31], v[60:63]
    ds_read_b128 v[192:195], v8 offset:20480
    v_cvt_pk_bf16_f32 v48, v48, v49
    v_mfma_f32_16x16x32_bf16 v[60:63], v[164:167], v[24:27], v[60:63]
    v_cvt_pk_bf16_f32 v49, v50, v51
    v_cvt_pk_bf16_f32 v50, v52, v53
    v_mfma_f32_16x16x32_bf16 v[60:63], v[152:155], v[20:23], v[60:63]
    v_cvt_pk_bf16_f32 v51, v54, v55
    s_waitcnt lgkmcnt(4)
    v_mfma_f32_16x16x32_bf16 v[72:75], v[152:155], v[24:27], v[72:75]
    ds_read_b128 v[196:199], v9 offset:23552
    ds_write_b128 v206, v[48:51] offset:0
    v_mfma_f32_16x16x32_bf16 v[72:75], v[164:167], v[28:31], v[72:75]
    v_cvt_pk_bf16_f32 v56, v56, v57
    v_cvt_pk_bf16_f32 v57, v58, v59
    v_mfma_f32_16x16x32_bf16 v[72:75], v[176:179], v[32:35], v[72:75]
    ds_write_b64 v207, v[56:57] offset:0
    v_mfma_f32_16x16x32_bf16 v[76:79], v[180:183], v[32:35], v[76:79]
    v_mfma_f32_16x16x32_bf16 v[76:79], v[168:171], v[28:31], v[76:79]
    v_mfma_f32_16x16x32_bf16 v[76:79], v[156:159], v[24:27], v[76:79]
    v_mfma_f32_16x16x32_bf16 v[80:83], v[160:163], v[24:27], v[80:83]
    v_cvt_pk_bf16_f32 v60, v60, v61
    v_cvt_pk_bf16_f32 v61, v62, v63
    v_mfma_f32_16x16x32_bf16 v[80:83], v[172:175], v[28:31], v[80:83]
    v_cvt_pk_bf16_f32 v62, v64, v65
    v_cvt_pk_bf16_f32 v63, v66, v67
    v_mfma_f32_16x16x32_bf16 v[80:83], v[184:187], v[32:35], v[80:83]
    ds_write_b128 v206, v[60:63] offset:3200
    s_waitcnt lgkmcnt(4)
    v_mfma_f32_16x16x32_bf16 v[84:87], a[0:3], v[36:39], 0
    v_cvt_pk_bf16_f32 v68, v68, v69
    v_cvt_pk_bf16_f32 v69, v70, v71
    v_mfma_f32_16x16x32_bf16 v[84:87], a[12:15], v[40:43], v[84:87]
    ds_write_b64 v207, v[68:69] offset:3200
    v_mfma_f32_16x16x32_bf16 v[84:87], a[24:27], v[44:47], v[84:87]
    v_mfma_f32_16x16x32_bf16 v[96:99], a[24:27], v[192:195], 0
    v_mfma_f32_16x16x32_bf16 v[96:99], a[12:15], v[44:47], v[96:99]
    v_mfma_f32_16x16x32_bf16 v[96:99], a[0:3], v[40:43], v[96:99]
    s_waitcnt lgkmcnt(4)
    v_mfma_f32_16x16x32_bf16 v[108:111], a[0:3], v[44:47], 0
    v_cvt_pk_bf16_f32 v72, v72, v73
    v_cvt_pk_bf16_f32 v73, v74, v75
    v_mfma_f32_16x16x32_bf16 v[108:111], a[12:15], v[192:195], v[108:111]
    v_cvt_pk_bf16_f32 v74, v76, v77
    v_cvt_pk_bf16_f32 v75, v78, v79
    v_mfma_f32_16x16x32_bf16 v[108:111], a[24:27], v[196:199], v[108:111]
    ds_write_b128 v206, v[72:75] offset:6400
    v_cvt_pk_bf16_f32 v80, v80, v81
    v_mfma_f32_16x16x32_bf16 v[112:115], a[28:31], v[196:199], 0
    v_cvt_pk_bf16_f32 v81, v82, v83
    ds_write_b64 v207, v[80:81] offset:6400
    v_mfma_f32_16x16x32_bf16 v[112:115], a[16:19], v[192:195], v[112:115]
    v_mfma_f32_16x16x32_bf16 v[112:115], a[4:7], v[44:47], v[112:115]
    v_mfma_f32_16x16x32_bf16 v[100:103], a[4:7], v[40:43], 0
    ds_read_b128 v[200:203], v9 offset:26880
    v_mfma_f32_16x16x32_bf16 v[100:103], a[16:19], v[44:47], v[100:103]
    ds_read_b128 v[16:19], v8 offset:20736
    v_mfma_f32_16x16x32_bf16 v[100:103], a[28:31], v[192:195], v[100:103]
    ds_read_b128 v[20:23], v9 offset:23808
    v_mfma_f32_16x16x32_bf16 v[88:91], a[28:31], v[44:47], 0
    ds_read_b128 v[24:27], v8 offset:23808
    v_mfma_f32_16x16x32_bf16 v[88:91], a[16:19], v[40:43], v[88:91]
    v_mfma_f32_16x16x32_bf16 v[88:91], a[4:7], v[36:39], v[88:91]
    v_mfma_f32_16x16x32_bf16 v[92:95], a[8:11], v[36:39], 0
    ds_read_b128 v[28:31], v7 offset:20736
    v_mfma_f32_16x16x32_bf16 v[92:95], a[20:23], v[40:43], v[92:95]
    v_mfma_f32_16x16x32_bf16 v[92:95], a[32:35], v[44:47], v[92:95]
    v_mfma_f32_16x16x32_bf16 v[104:107], a[32:35], v[192:195], 0
    v_mfma_f32_16x16x32_bf16 v[104:107], a[20:23], v[44:47], v[104:107]
    v_mfma_f32_16x16x32_bf16 v[104:107], a[8:11], v[40:43], v[104:107]
    v_mfma_f32_16x16x32_bf16 v[116:119], a[8:11], v[44:47], 0
    v_mfma_f32_16x16x32_bf16 v[116:119], a[20:23], v[192:195], v[116:119]
    v_mfma_f32_16x16x32_bf16 v[116:119], a[32:35], v[196:199], v[116:119]
    s_waitcnt lgkmcnt(1)
    v_mfma_f32_16x16x32_bf16 v[116:119], a[44:47], v[200:203], v[116:119]
    v_mfma_f32_16x16x32_bf16 v[116:119], a[56:59], v[16:19], v[116:119]
    v_mfma_f32_16x16x32_bf16 v[116:119], a[68:71], v[20:23], v[116:119]
    v_mfma_f32_16x16x32_bf16 v[104:107], a[68:71], v[16:19], v[104:107]
    v_mfma_f32_16x16x32_bf16 v[104:107], a[56:59], v[200:203], v[104:107]
    v_mfma_f32_16x16x32_bf16 v[104:107], a[44:47], v[24:27], v[104:107]
    s_waitcnt lgkmcnt(0)
    v_mfma_f32_16x16x32_bf16 v[92:95], a[44:47], v[28:31], v[92:95]
    v_mfma_f32_16x16x32_bf16 v[92:95], a[56:59], v[24:27], v[92:95]
    v_mfma_f32_16x16x32_bf16 v[92:95], a[68:71], v[200:203], v[92:95]
    v_mfma_f32_16x16x32_bf16 v[88:91], a[64:67], v[200:203], v[88:91]
    v_mfma_f32_16x16x32_bf16 v[88:91], a[52:55], v[24:27], v[88:91]
    v_mfma_f32_16x16x32_bf16 v[88:91], a[40:43], v[28:31], v[88:91]
    v_mfma_f32_16x16x32_bf16 v[100:103], a[40:43], v[24:27], v[100:103]
    ds_read_b128 v[32:35], v7 offset:20992
    v_mfma_f32_16x16x32_bf16 v[100:103], a[52:55], v[200:203], v[100:103]
    ds_read_b128 v[36:39], v8 offset:24064
    v_mfma_f32_16x16x32_bf16 v[100:103], a[64:67], v[16:19], v[100:103]
    ds_read_b128 v[40:43], v9 offset:27136
    v_mfma_f32_16x16x32_bf16 v[112:115], a[64:67], v[20:23], v[112:115]
    ds_read_b128 v[44:47], v8 offset:20992
    v_mfma_f32_16x16x32_bf16 v[112:115], a[52:55], v[16:19], v[112:115]
    v_mfma_f32_16x16x32_bf16 v[112:115], a[40:43], v[200:203], v[112:115]
    v_mfma_f32_16x16x32_bf16 v[108:111], a[36:39], v[200:203], v[108:111]
    ds_read_b128 v[192:195], v9 offset:24064
    v_mfma_f32_16x16x32_bf16 v[108:111], a[48:51], v[16:19], v[108:111]
    v_mfma_f32_16x16x32_bf16 v[108:111], a[60:63], v[20:23], v[108:111]
    v_mfma_f32_16x16x32_bf16 v[96:99], a[60:63], v[16:19], v[96:99]
    v_mfma_f32_16x16x32_bf16 v[96:99], a[48:51], v[200:203], v[96:99]
    v_mfma_f32_16x16x32_bf16 v[96:99], a[36:39], v[24:27], v[96:99]
    v_mfma_f32_16x16x32_bf16 v[84:87], a[36:39], v[28:31], v[84:87]
    v_mfma_f32_16x16x32_bf16 v[84:87], a[48:51], v[24:27], v[84:87]
    v_mfma_f32_16x16x32_bf16 v[84:87], a[60:63], v[200:203], v[84:87]
    s_waitcnt lgkmcnt(1)
    v_mfma_f32_16x16x32_bf16 v[84:87], a[72:75], v[32:35], v[84:87]
    v_mfma_f32_16x16x32_bf16 v[84:87], a[84:87], v[36:39], v[84:87]
    v_mfma_f32_16x16x32_bf16 v[84:87], a[96:99], v[40:43], v[84:87]
    v_mfma_f32_16x16x32_bf16 v[96:99], a[96:99], v[44:47], v[96:99]
    v_mfma_f32_16x16x32_bf16 v[96:99], a[84:87], v[40:43], v[96:99]
    v_mfma_f32_16x16x32_bf16 v[96:99], a[72:75], v[36:39], v[96:99]
    s_waitcnt lgkmcnt(0)
    v_mfma_f32_16x16x32_bf16 v[108:111], a[72:75], v[40:43], v[108:111]
    v_mfma_f32_16x16x32_bf16 v[108:111], a[84:87], v[44:47], v[108:111]
    v_mfma_f32_16x16x32_bf16 v[108:111], a[96:99], v[192:195], v[108:111]
    v_mfma_f32_16x16x32_bf16 v[112:115], a[100:103], v[192:195], v[112:115]
    v_mfma_f32_16x16x32_bf16 v[112:115], a[88:91], v[44:47], v[112:115]
    v_mfma_f32_16x16x32_bf16 v[112:115], a[76:79], v[40:43], v[112:115]
    s_waitcnt vmcnt(5)
    s_barrier
    v_mfma_f32_16x16x32_bf16 v[100:103], a[76:79], v[36:39], v[100:103]
    ds_read_b128 v[196:199], v9 offset:36864
    ds_read_b128 v[212:215], v208 offset:0
    v_mfma_f32_16x16x32_bf16 v[100:103], a[88:91], v[40:43], v[100:103]
    ds_read_b128 v[200:203], v8 offset:30720
    ds_read_b128 v[216:219], v209 offset:0
    v_mfma_f32_16x16x32_bf16 v[100:103], a[100:103], v[44:47], v[100:103]
    ds_read_b128 v[16:19], v9 offset:33792
    ds_read_b128 v[220:223], v210 offset:0
    v_mfma_f32_16x16x32_bf16 v[88:91], a[100:103], v[40:43], v[88:91]
    ds_read_b128 v[20:23], v8 offset:33792
    ds_read_b128 v[224:227], v232 offset:0
    v_mfma_f32_16x16x32_bf16 v[88:91], a[88:91], v[36:39], v[88:91]
    ds_read_b128 v[228:231], v233 offset:0
    v_mfma_f32_16x16x32_bf16 v[88:91], a[76:79], v[32:35], v[88:91]
    v_mfma_f32_16x16x32_bf16 v[92:95], a[80:83], v[32:35], v[92:95]
    ds_read_b128 v[24:27], v7 offset:30720
    s_waitcnt lgkmcnt(8)
    v_mfma_f32_16x16x32_bf16 v[92:95], a[92:95], v[36:39], v[92:95]
    buffer_store_dwordx4 v[212:215], v15, s[12:15], s33 offen offset:0 nt
    v_mfma_f32_16x16x32_bf16 v[92:95], a[104:107], v[40:43], v[92:95]
    s_waitcnt lgkmcnt(6)
    v_mfma_f32_16x16x32_bf16 v[104:107], a[104:107], v[44:47], v[104:107]
    v_mfma_f32_16x16x32_bf16 v[104:107], a[92:95], v[40:43], v[104:107]
    v_mfma_f32_16x16x32_bf16 v[104:107], a[80:83], v[36:39], v[104:107]
    v_mfma_f32_16x16x32_bf16 v[116:119], a[80:83], v[40:43], v[116:119]
    v_mfma_f32_16x16x32_bf16 v[116:119], a[92:95], v[44:47], v[116:119]
    v_mfma_f32_16x16x32_bf16 v[116:119], a[104:107], v[192:195], v[116:119]
    s_waitcnt lgkmcnt(3)
    v_mfma_f32_16x16x32_bf16 v[116:119], a[116:119], v[196:199], v[116:119]
    v_mfma_f32_16x16x32_bf16 v[116:119], a[128:131], v[200:203], v[116:119]
    v_mfma_f32_16x16x32_bf16 v[116:119], a[140:143], v[16:19], v[116:119]
    v_mfma_f32_16x16x32_bf16 v[104:107], a[140:143], v[200:203], v[104:107]
    v_mfma_f32_16x16x32_bf16 v[104:107], a[128:131], v[196:199], v[104:107]
    buffer_store_dwordx4 v[216:219], v15, s[12:15], s33 offen offset:1024 nt
    v_mfma_f32_16x16x32_bf16 v[104:107], a[116:119], v[20:23], v[104:107]
    s_waitcnt lgkmcnt(0)
    v_mfma_f32_16x16x32_bf16 v[92:95], a[116:119], v[24:27], v[92:95]
    v_mfma_f32_16x16x32_bf16 v[92:95], a[128:131], v[20:23], v[92:95]
    v_mfma_f32_16x16x32_bf16 v[92:95], a[140:143], v[196:199], v[92:95]
    v_mfma_f32_16x16x32_bf16 v[88:91], a[136:139], v[196:199], v[88:91]
    v_mfma_f32_16x16x32_bf16 v[88:91], a[124:127], v[20:23], v[88:91]
    v_mfma_f32_16x16x32_bf16 v[88:91], a[112:115], v[24:27], v[88:91]
    v_mfma_f32_16x16x32_bf16 v[100:103], a[112:115], v[20:23], v[100:103]
    ds_read_b128 v[28:31], v7 offset:30976
    v_mfma_f32_16x16x32_bf16 v[100:103], a[124:127], v[196:199], v[100:103]
    ds_read_b128 v[32:35], v8 offset:34048
    v_mfma_f32_16x16x32_bf16 v[100:103], a[136:139], v[200:203], v[100:103]
    ds_read_b128 v[36:39], v9 offset:37120
    v_mfma_f32_16x16x32_bf16 v[112:115], a[136:139], v[16:19], v[112:115]
    ds_read_b128 v[40:43], v8 offset:30976
    v_mfma_f32_16x16x32_bf16 v[112:115], a[124:127], v[200:203], v[112:115]
    buffer_store_dwordx4 v[220:223], v15, s[12:15], s33 offen offset:2048 nt
    v_mfma_f32_16x16x32_bf16 v[112:115], a[112:115], v[196:199], v[112:115]
    v_mfma_f32_16x16x32_bf16 v[108:111], a[108:111], v[196:199], v[108:111]
    ds_read_b128 v[44:47], v9 offset:34048
    v_mfma_f32_16x16x32_bf16 v[108:111], a[120:123], v[200:203], v[108:111]
    v_mfma_f32_16x16x32_bf16 v[108:111], a[132:135], v[16:19], v[108:111]
    v_mfma_f32_16x16x32_bf16 v[96:99], a[132:135], v[200:203], v[96:99]
    v_mfma_f32_16x16x32_bf16 v[96:99], a[120:123], v[196:199], v[96:99]
    v_mfma_f32_16x16x32_bf16 v[96:99], a[108:111], v[20:23], v[96:99]
    v_mfma_f32_16x16x32_bf16 v[84:87], a[108:111], v[24:27], v[84:87]
    v_mfma_f32_16x16x32_bf16 v[84:87], a[120:123], v[20:23], v[84:87]
    v_mfma_f32_16x16x32_bf16 v[84:87], a[132:135], v[196:199], v[84:87]
    s_waitcnt lgkmcnt(1)
    v_mfma_f32_16x16x32_bf16 v[84:87], a[144:147], v[28:31], v[84:87]
    v_mfma_f32_16x16x32_bf16 v[84:87], a[156:159], v[32:35], v[84:87]
    buffer_store_dwordx4 v[224:227], v15, s[12:15], s33 offen offset:3072 nt
    v_mfma_f32_16x16x32_bf16 v[84:87], a[168:171], v[36:39], v[84:87]
    v_mfma_f32_16x16x32_bf16 v[96:99], a[168:171], v[40:43], v[96:99]
    v_mfma_f32_16x16x32_bf16 v[96:99], a[156:159], v[36:39], v[96:99]
    v_mfma_f32_16x16x32_bf16 v[96:99], a[144:147], v[32:35], v[96:99]
    s_waitcnt lgkmcnt(0)
    v_mfma_f32_16x16x32_bf16 v[108:111], a[144:147], v[36:39], v[108:111]
    v_mfma_f32_16x16x32_bf16 v[108:111], a[156:159], v[40:43], v[108:111]
    v_mfma_f32_16x16x32_bf16 v[108:111], a[168:171], v[44:47], v[108:111]
    v_mfma_f32_16x16x32_bf16 v[112:115], a[172:175], v[44:47], v[112:115]
    v_mfma_f32_16x16x32_bf16 v[112:115], a[160:163], v[40:43], v[112:115]
    v_mfma_f32_16x16x32_bf16 v[112:115], a[148:151], v[36:39], v[112:115]
    v_mfma_f32_16x16x32_bf16 v[100:103], a[148:151], v[32:35], v[100:103]
    ds_read_b128 v[192:195], v9 offset:37376
    v_mfma_f32_16x16x32_bf16 v[100:103], a[160:163], v[36:39], v[100:103]
    ds_read_b128 v[196:199], v8 offset:31232
    v_mfma_f32_16x16x32_bf16 v[100:103], a[172:175], v[40:43], v[100:103]
    ds_read_b128 v[200:203], v9 offset:34304
    v_mfma_f32_16x16x32_bf16 v[88:91], a[172:175], v[36:39], v[88:91]
    ds_read_b128 v[16:19], v8 offset:34304
    v_mfma_f32_16x16x32_bf16 v[88:91], a[160:163], v[32:35], v[88:91]
    buffer_store_dwordx4 v[228:231], v188, s[12:15], s33 offen nt
    s_add_u32 s33, s33, s44
    v_mfma_f32_16x16x32_bf16 v[88:91], a[148:151], v[28:31], v[88:91]
    v_mfma_f32_16x16x32_bf16 v[92:95], a[152:155], v[28:31], v[92:95]
    ds_read_b128 v[20:23], v7 offset:31232
    v_mfma_f32_16x16x32_bf16 v[92:95], a[164:167], v[32:35], v[92:95]
    v_mfma_f32_16x16x32_bf16 v[92:95], a[176:179], v[36:39], v[92:95]
    v_mfma_f32_16x16x32_bf16 v[104:107], a[176:179], v[40:43], v[104:107]
    v_mfma_f32_16x16x32_bf16 v[104:107], a[164:167], v[36:39], v[104:107]
    v_mfma_f32_16x16x32_bf16 v[104:107], a[152:155], v[32:35], v[104:107]
    v_mfma_f32_16x16x32_bf16 v[116:119], a[152:155], v[36:39], v[116:119]
    v_mfma_f32_16x16x32_bf16 v[116:119], a[164:167], v[40:43], v[116:119]
    v_mfma_f32_16x16x32_bf16 v[116:119], a[176:179], v[44:47], v[116:119]
    s_waitcnt lgkmcnt(1)
    v_mfma_f32_16x16x32_bf16 v[116:119], a[188:191], v[192:195], v[116:119]
    v_mfma_f32_16x16x32_bf16 v[116:119], a[200:203], v[196:199], v[116:119]
    v_mfma_f32_16x16x32_bf16 v[116:119], a[212:215], v[200:203], v[116:119]
    v_mfma_f32_16x16x32_bf16 v[104:107], a[212:215], v[196:199], v[104:107]
    v_mfma_f32_16x16x32_bf16 v[104:107], a[200:203], v[192:195], v[104:107]
    v_mfma_f32_16x16x32_bf16 v[104:107], a[188:191], v[16:19], v[104:107]
    s_waitcnt lgkmcnt(0)
    v_mfma_f32_16x16x32_bf16 v[92:95], a[188:191], v[20:23], v[92:95]
    v_mfma_f32_16x16x32_bf16 v[92:95], a[200:203], v[16:19], v[92:95]
    v_mfma_f32_16x16x32_bf16 v[92:95], a[212:215], v[192:195], v[92:95]
    v_mfma_f32_16x16x32_bf16 v[88:91], a[208:211], v[192:195], v[88:91]
    v_mfma_f32_16x16x32_bf16 v[88:91], a[196:199], v[16:19], v[88:91]
    v_mfma_f32_16x16x32_bf16 v[88:91], a[184:187], v[20:23], v[88:91]
    v_mfma_f32_16x16x32_bf16 v[100:103], a[184:187], v[16:19], v[100:103]
    ds_read_b128 v[24:27], v7 offset:40960
    v_mfma_f32_16x16x32_bf16 v[100:103], a[196:199], v[192:195], v[100:103]
    ds_read_b128 v[28:31], v8 offset:44032
    v_mfma_f32_16x16x32_bf16 v[100:103], a[208:211], v[196:199], v[100:103]
    ds_read_b128 v[32:35], v9 offset:47104
    v_mfma_f32_16x16x32_bf16 v[112:115], a[208:211], v[200:203], v[112:115]
    ds_read_b128 v[36:39], v8 offset:40960
    v_mfma_f32_16x16x32_bf16 v[112:115], a[196:199], v[196:199], v[112:115]
    v_mfma_f32_16x16x32_bf16 v[112:115], a[184:187], v[192:195], v[112:115]
    v_mfma_f32_16x16x32_bf16 v[108:111], a[180:183], v[192:195], v[108:111]
    ds_read_b128 v[40:43], v9 offset:44032
    v_mfma_f32_16x16x32_bf16 v[108:111], a[192:195], v[196:199], v[108:111]
    v_mfma_f32_16x16x32_bf16 v[108:111], a[204:207], v[200:203], v[108:111]
    v_mfma_f32_16x16x32_bf16 v[96:99], a[204:207], v[196:199], v[96:99]
    v_mfma_f32_16x16x32_bf16 v[96:99], a[192:195], v[192:195], v[96:99]
    v_mfma_f32_16x16x32_bf16 v[96:99], a[180:183], v[16:19], v[96:99]
    v_mfma_f32_16x16x32_bf16 v[84:87], a[180:183], v[20:23], v[84:87]
    v_mfma_f32_16x16x32_bf16 v[84:87], a[192:195], v[16:19], v[84:87]
    v_mfma_f32_16x16x32_bf16 v[84:87], a[204:207], v[192:195], v[84:87]
    s_waitcnt lgkmcnt(1)
    v_mfma_f32_16x16x32_bf16 v[84:87], a[216:219], v[24:27], v[84:87]
    v_mfma_f32_16x16x32_bf16 v[84:87], a[228:231], v[28:31], v[84:87]
    v_mfma_f32_16x16x32_bf16 v[84:87], a[240:243], v[32:35], v[84:87]
    v_mfma_f32_16x16x32_bf16 v[96:99], a[240:243], v[36:39], v[96:99]
    v_mfma_f32_16x16x32_bf16 v[96:99], a[228:231], v[32:35], v[96:99]
    v_mfma_f32_16x16x32_bf16 v[96:99], a[216:219], v[28:31], v[96:99]
    s_waitcnt lgkmcnt(0)
    v_mfma_f32_16x16x32_bf16 v[108:111], a[216:219], v[32:35], v[108:111]
    v_mfma_f32_16x16x32_bf16 v[108:111], a[228:231], v[36:39], v[108:111]
    v_mfma_f32_16x16x32_bf16 v[108:111], a[240:243], v[40:43], v[108:111]
    v_mfma_f32_16x16x32_bf16 v[112:115], a[244:247], v[40:43], v[112:115]
    v_mfma_f32_16x16x32_bf16 v[112:115], a[232:235], v[36:39], v[112:115]
    v_mfma_f32_16x16x32_bf16 v[112:115], a[220:223], v[32:35], v[112:115]
    v_mfma_f32_16x16x32_bf16 v[100:103], a[220:223], v[28:31], v[100:103]
    ds_read_b128 v[44:47], v9 offset:47360
    v_mfma_f32_16x16x32_bf16 v[100:103], a[232:235], v[32:35], v[100:103]
    ds_read_b128 v[192:195], v8 offset:41216
    v_mfma_f32_16x16x32_bf16 v[100:103], a[244:247], v[36:39], v[100:103]
    ds_read_b128 v[196:199], v9 offset:44288
    v_mfma_f32_16x16x32_bf16 v[88:91], a[244:247], v[32:35], v[88:91]
    ds_read_b128 v[200:203], v8 offset:44288
    v_mfma_f32_16x16x32_bf16 v[88:91], a[232:235], v[28:31], v[88:91]
    v_mfma_f32_16x16x32_bf16 v[88:91], a[220:223], v[24:27], v[88:91]
    v_mfma_f32_16x16x32_bf16 v[92:95], a[224:227], v[24:27], v[92:95]
    ds_read_b128 v[16:19], v7 offset:41216
    v_mfma_f32_16x16x32_bf16 v[92:95], a[236:239], v[28:31], v[92:95]
    v_mfma_f32_16x16x32_bf16 v[92:95], a[248:251], v[32:35], v[92:95]
    v_mfma_f32_16x16x32_bf16 v[104:107], a[248:251], v[36:39], v[104:107]
    v_mfma_f32_16x16x32_bf16 v[104:107], a[236:239], v[32:35], v[104:107]
    v_mfma_f32_16x16x32_bf16 v[104:107], a[224:227], v[28:31], v[104:107]
    v_mfma_f32_16x16x32_bf16 v[116:119], a[224:227], v[32:35], v[116:119]
    v_mfma_f32_16x16x32_bf16 v[116:119], a[236:239], v[36:39], v[116:119]
    v_mfma_f32_16x16x32_bf16 v[116:119], a[248:251], v[40:43], v[116:119]
    s_waitcnt lgkmcnt(1)
    v_mfma_f32_16x16x32_bf16 v[116:119], v[124:127], v[44:47], v[116:119]
    v_mfma_f32_16x16x32_bf16 v[116:119], v[136:139], v[192:195], v[116:119]
    v_mfma_f32_16x16x32_bf16 v[116:119], v[148:151], v[196:199], v[116:119]
    v_mfma_f32_16x16x32_bf16 v[104:107], v[148:151], v[192:195], v[104:107]
    v_mfma_f32_16x16x32_bf16 v[104:107], v[136:139], v[44:47], v[104:107]
    v_mfma_f32_16x16x32_bf16 v[104:107], v[124:127], v[200:203], v[104:107]
    s_waitcnt lgkmcnt(0)
    v_mfma_f32_16x16x32_bf16 v[92:95], v[124:127], v[16:19], v[92:95]
    v_mfma_f32_16x16x32_bf16 v[92:95], v[136:139], v[200:203], v[92:95]
    v_mfma_f32_16x16x32_bf16 v[92:95], v[148:151], v[44:47], v[92:95]
    v_mfma_f32_16x16x32_bf16 v[88:91], v[144:147], v[44:47], v[88:91]
    v_mfma_f32_16x16x32_bf16 v[88:91], v[132:135], v[200:203], v[88:91]
    v_mfma_f32_16x16x32_bf16 v[88:91], v[120:123], v[16:19], v[88:91]
    v_mfma_f32_16x16x32_bf16 v[100:103], v[120:123], v[200:203], v[100:103]
    ds_read_b128 v[20:23], v7 offset:41472
    v_mfma_f32_16x16x32_bf16 v[100:103], v[132:135], v[44:47], v[100:103]
    ds_read_b128 v[24:27], v8 offset:44544
    v_mfma_f32_16x16x32_bf16 v[100:103], v[144:147], v[192:195], v[100:103]
    ds_read_b128 v[28:31], v9 offset:47616
    v_mfma_f32_16x16x32_bf16 v[112:115], v[144:147], v[196:199], v[112:115]
    v_mfma_f32_16x16x32_bf16 v[112:115], v[132:135], v[192:195], v[112:115]
    v_mfma_f32_16x16x32_bf16 v[112:115], v[120:123], v[44:47], v[112:115]
    v_mfma_f32_16x16x32_bf16 v[108:111], a[252:255], v[44:47], v[108:111]
    v_mfma_f32_16x16x32_bf16 v[108:111], v[128:131], v[192:195], v[108:111]
    v_mfma_f32_16x16x32_bf16 v[108:111], v[140:143], v[196:199], v[108:111]
    v_mfma_f32_16x16x32_bf16 v[96:99], v[140:143], v[192:195], v[96:99]
    ds_read_b128 v[32:35], v8 offset:41472
    v_mfma_f32_16x16x32_bf16 v[96:99], v[128:131], v[44:47], v[96:99]
    v_mfma_f32_16x16x32_bf16 v[96:99], a[252:255], v[200:203], v[96:99]
    v_mfma_f32_16x16x32_bf16 v[84:87], a[252:255], v[16:19], v[84:87]
    v_mfma_f32_16x16x32_bf16 v[84:87], v[128:131], v[200:203], v[84:87]
    v_mfma_f32_16x16x32_bf16 v[84:87], v[140:143], v[44:47], v[84:87]
    s_waitcnt lgkmcnt(1)
    v_mfma_f32_16x16x32_bf16 v[84:87], v[152:155], v[20:23], v[84:87]
    v_mfma_f32_16x16x32_bf16 v[84:87], v[164:167], v[24:27], v[84:87]
    v_mfma_f32_16x16x32_bf16 v[84:87], v[176:179], v[28:31], v[84:87]
    v_mfma_f32_16x16x32_bf16 v[88:91], v[180:183], v[28:31], v[88:91]
    ds_read_b128 v[36:39], v9 offset:44544
    v_mfma_f32_16x16x32_bf16 v[88:91], v[168:171], v[24:27], v[88:91]
    v_mfma_f32_16x16x32_bf16 v[88:91], v[156:159], v[20:23], v[88:91]
    v_mfma_f32_16x16x32_bf16 v[92:95], v[160:163], v[20:23], v[92:95]
    v_mfma_f32_16x16x32_bf16 v[92:95], v[172:175], v[24:27], v[92:95]
    v_mfma_f32_16x16x32_bf16 v[92:95], v[184:187], v[28:31], v[92:95]
    s_waitcnt lgkmcnt(1)
    v_mfma_f32_16x16x32_bf16 v[96:99], v[176:179], v[32:35], v[96:99]
    v_mfma_f32_16x16x32_bf16 v[96:99], v[164:167], v[28:31], v[96:99]
    v_mfma_f32_16x16x32_bf16 v[96:99], v[152:155], v[24:27], v[96:99]
    v_mfma_f32_16x16x32_bf16 v[100:103], v[156:159], v[24:27], v[100:103]
    v_mfma_f32_16x16x32_bf16 v[100:103], v[168:171], v[28:31], v[100:103]
    v_mfma_f32_16x16x32_bf16 v[100:103], v[180:183], v[32:35], v[100:103]
    v_mfma_f32_16x16x32_bf16 v[104:107], v[184:187], v[32:35], v[104:107]
    v_cvt_pk_bf16_f32 v84, v84, v85
    v_cvt_pk_bf16_f32 v85, v86, v87
    v_mfma_f32_16x16x32_bf16 v[104:107], v[172:175], v[28:31], v[104:107]
    v_cvt_pk_bf16_f32 v86, v88, v89
    v_cvt_pk_bf16_f32 v87, v90, v91
    v_mfma_f32_16x16x32_bf16 v[104:107], v[160:163], v[24:27], v[104:107]
    ds_write_b128 v206, v[84:87] offset:20480
    s_waitcnt lgkmcnt(1)
    v_mfma_f32_16x16x32_bf16 v[108:111], v[152:155], v[28:31], v[108:111]
    v_cvt_pk_bf16_f32 v92, v92, v93
    v_cvt_pk_bf16_f32 v93, v94, v95
    v_mfma_f32_16x16x32_bf16 v[108:111], v[164:167], v[32:35], v[108:111]
    ds_write_b64 v207, v[92:93] offset:20480
    v_mfma_f32_16x16x32_bf16 v[108:111], v[176:179], v[36:39], v[108:111]
    v_mfma_f32_16x16x32_bf16 v[112:115], v[180:183], v[36:39], v[112:115]
    v_mfma_f32_16x16x32_bf16 v[112:115], v[168:171], v[32:35], v[112:115]
    v_mfma_f32_16x16x32_bf16 v[112:115], v[156:159], v[28:31], v[112:115]
    v_mfma_f32_16x16x32_bf16 v[116:119], v[160:163], v[28:31], v[116:119]
    v_cvt_pk_bf16_f32 v96, v96, v97
    v_cvt_pk_bf16_f32 v97, v98, v99
    v_mfma_f32_16x16x32_bf16 v[116:119], v[172:175], v[32:35], v[116:119]
    v_cvt_pk_bf16_f32 v98, v100, v101
    v_cvt_pk_bf16_f32 v99, v102, v103
    v_mfma_f32_16x16x32_bf16 v[116:119], v[184:187], v[36:39], v[116:119]
    ds_write_b128 v206, v[96:99] offset:23680
    v_cvt_pk_bf16_f32 v104, v104, v105
    v_cvt_pk_bf16_f32 v105, v106, v107
    ds_write_b64 v207, v[104:105] offset:23680
    v_cvt_pk_bf16_f32 v108, v108, v109
    v_cvt_pk_bf16_f32 v109, v110, v111
    v_cvt_pk_bf16_f32 v110, v112, v113
    v_cvt_pk_bf16_f32 v111, v114, v115
    ds_write_b128 v206, v[108:111] offset:26880
    v_cvt_pk_bf16_f32 v116, v116, v117
    v_cvt_pk_bf16_f32 v117, v118, v119
    ds_write_b64 v207, v[116:117] offset:26880
    s_waitcnt lgkmcnt(0)
    s_barrier
    ds_read_b128 v[212:215], v208 offset:20480
    ds_read_b128 v[216:219], v209 offset:20480
    ds_read_b128 v[220:223], v210 offset:20480
    ds_read_b128 v[224:227], v232 offset:20480
    ds_read_b128 v[228:231], v233 offset:20480
    s_waitcnt lgkmcnt(4)
    buffer_store_dwordx4 v[212:215], v15, s[12:15], s33 offen offset:0 nt
    s_waitcnt lgkmcnt(3)
    buffer_store_dwordx4 v[216:219], v15, s[12:15], s33 offen offset:1024 nt
    s_waitcnt lgkmcnt(2)
    buffer_store_dwordx4 v[220:223], v15, s[12:15], s33 offen offset:2048 nt
    s_waitcnt lgkmcnt(1)
    buffer_store_dwordx4 v[224:227], v15, s[12:15], s33 offen offset:3072 nt
    s_waitcnt lgkmcnt(0)
    buffer_store_dwordx4 v[228:231], v188, s[12:15], s33 offen nt
    s_add_u32 s33, s33, s44
L_end:
    s_endpgm
.section .rodata,"a"
.p2align 6
.amdhsa_kernel standalone__dilated_atrous__vision_kernel
  .amdhsa_next_free_vgpr 512
  .amdhsa_next_free_sgpr 100
  .amdhsa_accum_offset 256
  .amdhsa_group_segment_fixed_size 0
  .amdhsa_kernarg_size 40
  .amdhsa_user_sgpr_count 2
  .amdhsa_user_sgpr_kernarg_segment_ptr 1
  .amdhsa_system_sgpr_workgroup_id_x 1
.end_amdhsa_kernel
```
